```python
import torch

def _softmax(x, axis=-1):
    return torch.softmax(x, dim=axis)
def _gelu(x):
    return torch.nn.functional.gelu(x, approximate="tanh")
def _silu(x):
    return torch.nn.functional.silu(x)
def _sigmoid(x):
    return torch.sigmoid(x)
def _layernorm(x, axis=-1, eps=1e-5):
    m = x.mean(dim=axis, keepdim=True)
    v = x.var(dim=axis, keepdim=True, unbiased=False)
    return (x - m) / torch.sqrt(v + eps)
def _scatter_add(tgt, idx, src, axis=0):
    return tgt.clone().index_add_(axis, idx, src)
def _segment_sum(src, seg, n):
    out = torch.zeros((n,) + src.shape[1:], dtype=src.dtype)
    return out.index_add_(0, seg, src)
def _pad(x, pw):
    flat = tuple(v for pair in reversed(pw) for v in pair)
    return torch.nn.functional.pad(x, flat)

kernel_name = 'parallel_sum__gqa_block_cached__dense_activation_squared_relu__decode'

def setup_inputs():

    _w = (lambda a: (lambda t: t.to(torch.bfloat16) if t.is_floating_point() else t)(torch.as_tensor(a)))
    def _A_setup():
        B, Sq, D = 2, 1, 576
        Hq, Hkv, Sk, Dh = 32, 16, 32768, 128
        assert Hq % Hkv == 0, (Hq, Hkv)
        return {
            "x": _w((lambda *s: torch.randn(*s, dtype=torch.bfloat16) * 0.05)(B, Sq, D)),
            "k_cache": _w((lambda *s: torch.randn(*s, dtype=torch.bfloat16) * 3.2)(B, Hkv, Sk, Dh)),
            "v_cache": _w((lambda *s: torch.randn(*s, dtype=torch.bfloat16) * 1.6)(B, Hkv, Sk, Dh)),
            "wq": _w((lambda *s: torch.randn(*s, dtype=torch.bfloat16) * 3.2)(D, Hq * Dh) * (D ** -0.5)),
            "wo": _w((lambda *s: torch.randn(*s, dtype=torch.bfloat16) * 1.6)(Hq * Dh, D) * ((Hq * Dh) ** -0.5)),
        }
    _A_in = _A_setup()

    def _B_setup():
        B, S, D, F = 2, 1, 576, 4608
        return {
            "x": _w((lambda *s: torch.randn(*s, dtype=torch.bfloat16) * 0.05)(B, S, D)),
            "w1": _w((lambda *s: torch.randn(*s, dtype=torch.bfloat16) * 0.05)(D, F)),
            "b1": _w((lambda *s: torch.randn(*s, dtype=torch.bfloat16) * 0.05)(F)),
            "w2": _w((lambda *s: torch.randn(*s, dtype=torch.bfloat16) * 0.05)(F, D)),
            "b2": _w((lambda *s: torch.randn(*s, dtype=torch.bfloat16) * 0.05)(D)),
        }
    _B_in = _B_setup()

    return {
        "A_x": _A_in["x"],
        "A_k_cache": _A_in["k_cache"],
        "A_v_cache": _A_in["v_cache"],
        "A_wq": _A_in["wq"],
        "A_wo": _A_in["wo"],
        "B_x": _B_in["x"],
        "B_w1": _B_in["w1"],
        "B_b1": _B_in["b1"],
        "B_w2": _B_in["w2"],
        "B_b2": _B_in["b2"],
    }

def reference(A_x, A_k_cache, A_v_cache, A_wq, A_wo, B_x, B_w1, B_b1, B_w2, B_b2):
    def _A_ref(x, k_cache, v_cache, wq, wo):
        B, Sq, D = x.shape
        Hq, Dh = 32, 128
        Hkv = k_cache.shape[1]
        rep = Hq // Hkv
        q = (lambda x, *d: x.permute(*d))((x @ wq).reshape(B, Sq, Hq, Dh), 0, 2, 1, 3)
        k = (lambda x, n, axis: torch.repeat_interleave(x, n, dim=axis))(k_cache, rep, axis=1)
        v = (lambda x, n, axis: torch.repeat_interleave(x, n, dim=axis))(v_cache, rep, axis=1)
        scores = torch.einsum("bhqd,bhkd->bhqk", q, k) * (Dh ** -0.5)
        p = _softmax(scores, axis=-1)
        o = torch.einsum("bhqk,bhkd->bhqd", p, v)
        return (lambda x, *d: x.permute(*d))(o, 0, 2, 1, 3).reshape(B, Sq, Hq * Dh) @ wo

    def _B_ref(x, w1, b1, w2, b2):
        h = torch.einsum("bsd,df->bsf", x, w1) + b1
        zero = torch.zeros_like(h)
        r = torch.where(h > zero, h, zero)
        h = r * r
        out = torch.einsum("bsf,fd->bsd", h, w2) + b2
        return out

    x = A_x
    xn = _layernorm(x, axis=-1)
    return x + _A_ref(xn, A_k_cache, A_v_cache, A_wq, A_wo) + _B_ref(xn, B_w1, B_b1, B_w2, B_b2)
```

```asm
; @launch grid=(256,1,1) block=(512,1,1) lds=23808
.amdgcn_target "amdgcn-amd-amdhsa--gfx950"
.text
.globl parallel_sum__gqa_block_cached__dense_activation_squared_relu__decode_kernel
.p2align 8
.type parallel_sum__gqa_block_cached__dense_activation_squared_relu__decode_kernel,@function
parallel_sum__gqa_block_cached__dense_activation_squared_relu__decode_kernel:
  s_cmp_ge_u32 s2, 256
  s_cbranch_scc1 L_end
  s_load_dwordx16 s[16:31], s[0:1], 0
  s_load_dwordx8 s[32:39], s[0:1], 64
  s_load_dwordx2 s[40:41], s[0:1], 96
  v_lshrrev_b32 v1, 6, v0
  v_and_b32 v0, 63, v0
  v_readfirstlane_b32 s3, v1
  s_lshr_b32 s7, s2, 3
  s_and_b32 s6, s2, 7
  s_and_b32 s4, s7, 15
  s_lshr_b32 s5, s7, 4
  v_and_b32 v2, 15, v0
  v_lshrrev_b32 v3, 4, v0
  s_mov_b32 s59, 0x05040100
  s_mov_b32 s60, 0x07060302
  s_mov_b32 s58, 0x3fb8aa3b
  s_cmp_ge_u32 s3, 4
  s_cbranch_scc1 L_aux
  v_lshlrev_b32 v4, 8, v2
  v_lshl_add_u32 v4, v3, 4, v4
  v_lshlrev_b32 v5, 10, v3
  v_lshl_add_u32 v5, v2, 4, v5
  s_lshl_b32 s8, s7, 23
  s_lshl_b32 s9, s6, 20
  s_lshl_b32 s66, s3, 13
  s_add_u32 s66, s66, s9
  s_mul_i32 s63, s7, 5
  s_and_b32 s63, s63, 31
  s_lshl_b32 s63, s63, 15
  s_mov_b32 s67, s63
  s_add_u32 s56, s66, s63
  s_add_u32 s57, s56, 4096
  s_mov_b32 s46, 0x800000
  s_mov_b32 s47, 0x20000
  s_mov_b32 s50, 0x800000
  s_mov_b32 s51, 0x20000
  s_mov_b32 s54, 0x40000000
  s_mov_b32 s55, 0x20000
  s_lshl_b32 s62, s7, 8
  s_add_u32 s62, s62, 278528
  v_mov_b32 v226, 0
  s_mov_b32 s69, 0x3db504f3
  s_waitcnt lgkmcnt(0)
  s_mov_b32 s52, s40
  s_mov_b32 s53, s41
  s_add_u32 s44, s18, s8
  s_addc_u32 s45, s19, 0
  s_add_u32 s48, s20, s8
  s_addc_u32 s49, s21, 0
  s_barrier
  s_barrier
  buffer_load_dwordx4 v[96:99], v4, s[44:47], s56 offen offset:0 nt
  buffer_load_dwordx4 v[100:103], v4, s[44:47], s56 offen offset:64 nt
  buffer_load_dwordx4 v[104:107], v4, s[44:47], s56 offen offset:128 nt
  buffer_load_dwordx4 v[108:111], v4, s[44:47], s56 offen offset:192 nt
  buffer_load_dwordx4 v[112:115], v4, s[44:47], s57 offen offset:0 nt
  buffer_load_dwordx4 v[116:119], v4, s[44:47], s57 offen offset:64 nt
  buffer_load_dwordx4 v[120:123], v4, s[44:47], s57 offen offset:128 nt
  buffer_load_dwordx4 v[124:127], v4, s[44:47], s57 offen offset:192 nt
  buffer_load_dwordx4 v[160:163], v5, s[48:51], s56 offen offset:0 nt
  buffer_load_dwordx4 v[164:167], v5, s[48:51], s56 offen offset:256 nt
  buffer_load_dwordx4 v[168:171], v5, s[48:51], s56 offen offset:512 nt
  buffer_load_dwordx4 v[172:175], v5, s[48:51], s56 offen offset:768 nt
  buffer_load_dwordx4 v[176:179], v5, s[48:51], s57 offen offset:0 nt
  buffer_load_dwordx4 v[180:183], v5, s[48:51], s57 offen offset:256 nt
  buffer_load_dwordx4 v[184:187], v5, s[48:51], s57 offen offset:512 nt
  buffer_load_dwordx4 v[188:191], v5, s[48:51], s57 offen offset:768 nt
  s_add_u32 s63, s63, 0x8000
  s_and_b32 s63, s63, 0xf8000
  s_add_u32 s56, s66, s63
  s_add_u32 s57, s56, 4096
  buffer_load_dwordx4 v[128:131], v4, s[44:47], s56 offen offset:0 nt
  buffer_load_dwordx4 v[132:135], v4, s[44:47], s56 offen offset:64 nt
  buffer_load_dwordx4 v[136:139], v4, s[44:47], s56 offen offset:128 nt
  buffer_load_dwordx4 v[140:143], v4, s[44:47], s56 offen offset:192 nt
  buffer_load_dwordx4 v[144:147], v4, s[44:47], s57 offen offset:0 nt
  buffer_load_dwordx4 v[148:151], v4, s[44:47], s57 offen offset:64 nt
  buffer_load_dwordx4 v[152:155], v4, s[44:47], s57 offen offset:128 nt
  buffer_load_dwordx4 v[156:159], v4, s[44:47], s57 offen offset:192 nt
  buffer_load_dwordx4 v[192:195], v5, s[48:51], s56 offen offset:0 nt
  buffer_load_dwordx4 v[196:199], v5, s[48:51], s56 offen offset:256 nt
  buffer_load_dwordx4 v[200:203], v5, s[48:51], s56 offen offset:512 nt
  buffer_load_dwordx4 v[204:207], v5, s[48:51], s56 offen offset:768 nt
  buffer_load_dwordx4 v[208:211], v5, s[48:51], s57 offen offset:0 nt
  buffer_load_dwordx4 v[212:215], v5, s[48:51], s57 offen offset:256 nt
  buffer_load_dwordx4 v[216:219], v5, s[48:51], s57 offen offset:512 nt
  buffer_load_dwordx4 v[220:223], v5, s[48:51], s57 offen offset:768 nt
  s_add_u32 s63, s63, 0x8000
  s_and_b32 s63, s63, 0xf8000
  s_add_u32 s56, s66, s63
  s_add_u32 s57, s56, 4096
  s_branch L_att_main
L_aux:
  s_sub_u32 s3, s3, 4
  s_lshl_b32 s62, s5, 3
  s_add_u32 s62, s62, s6
  s_add_u32 s61, s6, s4
  s_and_b32 s61, s61, 7
  s_lshl_b32 s64, s61, 5
  s_add_u32 s64, s64, s7
  s_add_u32 s65, s64, 224
  s_cmp_eq_u32 s3, 1
  s_cbranch_scc1 L_qunit
  s_setprio 2
  s_cmp_lg_u32 s3, 0
  s_cbranch_scc1 L_aux23
  v_mov_b32 v4, 0
  v_mov_b32 v5, 512
  ds_write_b32 v5, v4
  ds_write_b32 v5, v4 offset:4
  v_mov_b32 v24, -1
  v_mov_b32 v25, -1
  v_mov_b32 v26, -1
  v_mov_b32 v27, -1
  s_cmp_ge_u32 s64, 72
  s_cselect_b32 s10, 1, 0
  s_cmp_ge_u32 s64, 144
  s_cselect_b32 s10, 2, s10
  s_cmp_ge_u32 s64, 216
  s_cselect_b32 s10, 3, s10
  s_mul_i32 s11, s10, 72
  s_sub_u32 s11, s64, s11
  s_mul_i32 s10, s10, 36864
  s_lshl_b32 s11, s11, 8
  s_add_u32 s10, s10, s11
  s_add_u32 s10, s10, 425984
  s_cmp_ge_u32 s65, 72
  s_cselect_b32 s11, 1, 0
  s_cmp_ge_u32 s65, 144
  s_cselect_b32 s11, 2, s11
  s_cmp_ge_u32 s65, 216
  s_cselect_b32 s11, 3, s11
  s_mul_i32 s13, s11, 72
  s_sub_u32 s13, s65, s13
  s_mul_i32 s11, s11, 36864
  s_lshl_b32 s13, s13, 8
  s_add_u32 s11, s11, s13
  s_add_u32 s11, s11, 425984
  s_and_b32 s8, s62, 3
  s_lshl_b32 s8, s8, 8
  s_lshr_b32 s9, s62, 2
  s_lshl_b32 s9, s9, 10
  s_add_u32 s8, s8, s9
  s_lshl_b32 s9, s4, 13
  s_add_u32 s8, s8, s9
  s_add_u32 s8, s8, 294912
  v_and_b32 v6, 1, v3
  v_lshlrev_b32 v7, 4, v2
  v_lshl_add_u32 v8, v6, 12, v7
  v_add_u32 v8, s8, v8
  v_mul_u32_u24 v9, 18432, v6
  v_add_u32 v9, v9, v7
  v_add_u32 v10, s11, v9
  v_add_u32 v9, s10, v9
  v_cmp_gt_u32 vcc, 32, v0
  s_nop 1
  v_cndmask_b32 v9, v9, v8, vcc
  s_lshl_b32 s13, s61, 15
  s_lshl_b32 s14, s4, 10
  s_add_u32 s13, s13, s14
  s_lshl_b32 s14, s5, 9
  s_add_u32 s13, s13, s14
  s_add_u32 s13, s13, 589824
  v_lshrrev_b32 v11, 5, v0
  v_lshlrev_b32 v11, 14, v11
  v_and_b32 v6, 31, v0
  v_lshl_add_u32 v11, v6, 4, v11
  s_lshl_b32 s8, s7, 13
  s_lshl_b32 s9, s6, 10
  s_add_u32 s8, s8, s9
  v_lshlrev_b32 v12, 4, v0
  s_lshl_b32 s9, s7, 7
  s_lshl_b32 s14, s6, 3
  s_add_u32 s9, s9, s14
  s_add_u32 s9, s9, 262144
  v_lshlrev_b32 v13, 6, v0
  s_mov_b32 s70, -1
  s_cmp_eq_u32 s61, 7
  s_cselect_b32 s70, 0, s70
  s_mov_b32 s54, 0x40000000
  s_mov_b32 s55, 0x20000
  s_waitcnt lgkmcnt(0)
  s_mov_b32 s52, s40
  s_mov_b32 s53, s41
  s_mov_b32 exec_hi, s70
  buffer_store_dwordx4 v[24:27], v9, s[52:55], 0 offen sc0 sc1
  s_mov_b64 exec, -1
  buffer_store_dwordx4 v[24:27], v12, s[52:55], s8 offen sc0 sc1
  buffer_store_dwordx4 v[24:27], v11, s[52:55], s13 offen sc0 sc1
  s_mov_b64 exec, 3
  buffer_store_dwordx2 v[24:25], v13, s[52:55], s9 offen sc0 sc1
  s_cmp_lg_u32 s6, 0
  s_cbranch_scc1 L_noctr
  s_mov_b64 exec, 1
  v_mov_b32 v28, 0
  s_lshl_b32 s14, s7, 8
  s_add_u32 s14, s14, 278528
  buffer_store_dword v28, v28, s[52:55], s14 offen sc0 sc1
L_noctr:
  s_cmp_lt_u32 s61, 2
  s_cbranch_scc0 L_noh2reset
  s_mov_b32 exec_hi, 0
  s_mov_b32 exec_lo, -1
  buffer_store_dwordx4 v[24:27], v10, s[52:55], 0 offen sc0 sc1
  s_nop 1
L_noh2reset:
  s_mov_b64 exec, -1
  s_barrier
  s_mov_b64 exec, 1
  s_lshl_b32 s11, s4, 4
  v_mov_b32 v14, s11
  v_mov_b32 v15, 1
  s_waitcnt vmcnt(0)
  global_atomic_add v14, v15, s[38:39] sc1
  ds_write_b32 v5, v15
  s_barrier
  s_sleep 24
  s_mov_b32 s12, 65536
L_fam_poll:
  global_load_dword v16, v14, s[38:39] sc1
  s_waitcnt vmcnt(0)
  v_readfirstlane_b32 s8, v16
  s_nop 0
  s_cmp_ge_u32 s8, 16
  s_nop 2
  s_cbranch_scc1 L_fam_ok
  s_sleep 8
  s_sub_u32 s12, s12, 1
  s_cmp_lg_u32 s12, 0
  s_cbranch_scc1 L_fam_poll
L_fam_ok:
  s_mov_b64 exec, -1
  s_lshl_b32 s8, s4, 13
  s_lshl_b32 s9, s5, 12
  s_add_u32 s8, s8, s9
  s_add_u32 s8, s8, 294912
  s_mov_b32 s12, 65536
L_q_poll:
  buffer_load_dwordx4 v[16:19], v12, s[52:55], s8 offen offset:0 sc0 sc1
  buffer_load_dwordx4 v[20:23], v12, s[52:55], s8 offen offset:1024 sc0 sc1
  buffer_load_dwordx4 v[24:27], v12, s[52:55], s8 offen offset:2048 sc0 sc1
  buffer_load_dwordx4 v[28:31], v12, s[52:55], s8 offen offset:3072 sc0 sc1
  s_waitcnt vmcnt(0)
  v_max3_u32 v32, v16, v17, v18
  v_max3_u32 v32, v32, v19, v20
  v_max3_u32 v32, v32, v21, v22
  v_max3_u32 v32, v32, v23, v24
  v_max3_u32 v32, v32, v25, v26
  v_max3_u32 v32, v32, v27, v28
  v_max3_u32 v32, v32, v29, v30
  v_max_u32 v32, v32, v31
  v_cmp_eq_u32 vcc, -1, v32
  s_nop 4
  s_cbranch_vccz L_q_ok
  s_sleep 1
  s_sub_u32 s12, s12, 1
  s_cmp_lg_u32 s12, 0
  s_cbranch_scc1 L_q_poll
L_q_ok:
  v_add_f32 v16, v16, v20
  v_add_f32 v24, v24, v28
  v_add_f32 v16, v16, v24
  v_add_f32 v17, v17, v21
  v_add_f32 v25, v25, v29
  v_add_f32 v17, v17, v25
  v_add_f32 v18, v18, v22
  v_add_f32 v26, v26, v30
  v_add_f32 v18, v18, v26
  v_add_f32 v19, v19, v23
  v_add_f32 v27, v27, v31
  v_add_f32 v19, v19, v27
  v_cvt_pk_bf16_f32 v34, v16, v17
  v_cvt_pk_bf16_f32 v35, v18, v19
  v_lshlrev_b32 v33, 3, v0
  ds_write_b64 v33, v[34:35] offset:0
  s_waitcnt lgkmcnt(0)
  s_barrier
  s_branch L_aux2
L_qunit:
  s_setprio 3
  s_lshr_b32 s15, s62, 2
  s_mul_i32 s9, s15, 1179648
  s_lshl_b32 s8, s4, 9
  s_add_u32 s8, s8, s9
  s_and_b32 s9, s62, 3
  s_lshl_b32 s9, s9, 7
  s_add_u32 s8, s8, s9
  v_lshrrev_b32 v6, 5, v0
  v_mul_u32_u24 v6, 1152, v6
  v_and_b32 v7, 31, v0
  v_lshl_add_u32 v6, v7, 3, v6
  v_add_u32 v7, 0x400, v6
  v_and_b32 v8, 16, v0
  v_cmp_eq_u32 vcc, 0, v8
  v_mov_b32 v9, 0x40000000
  s_nop 0
  v_cndmask_b32 v7, v9, v7, vcc
  v_lshrrev_b32 v8, 3, v2
  v_mul_u32_u24 v8, 72, v8
  v_lshl_add_u32 v8, v3, 3, v8
  v_mul_u32_u24 v8, 8192, v8
  v_and_b32 v10, 7, v2
  v_lshl_add_u32 v8, v10, 4, v8
  v_add_u32 v8, s8, v8
  v_cmp_gt_u32 vcc, 16, v0
  s_nop 1
  v_cndmask_b32 v5, v9, v8, vcc
  s_mov_b32 s46, 2304
  s_mov_b32 s47, 0x20000
  s_mov_b32 s50, 4718592
  s_mov_b32 s51, 0x20000
  s_mov_b32 s54, 0x40000000
  s_mov_b32 s55, 0x20000
  s_waitcnt lgkmcnt(0)
  s_mov_b32 s44, s16
  s_mov_b32 s45, s17
  s_mov_b32 s48, s22
  s_mov_b32 s49, s23
  s_mov_b32 s52, s40
  s_mov_b32 s53, s41
  s_barrier
  buffer_load_dwordx2 v[16:17], v6, s[44:47], 0 offen offset:0
  buffer_load_dwordx2 v[18:19], v6, s[44:47], 0 offen offset:256
  buffer_load_dwordx2 v[20:21], v6, s[44:47], 0 offen offset:512
  buffer_load_dwordx2 v[22:23], v6, s[44:47], 0 offen offset:768
  buffer_load_dwordx2 v[24:25], v7, s[44:47], 0 offen
  v_add_u32 v9, 8192, v8
  v_add_u32 v10, 8192, v9
  v_add_u32 v11, 8192, v10
  v_add_u32 v12, 8192, v11
  v_add_u32 v13, 8192, v12
  v_add_u32 v14, 8192, v13
  v_add_u32 v15, 8192, v14
  s_mov_b32 s10, 0
  buffer_load_dwordx4 v[96:99], v8, s[48:51], s10 offen nt
  buffer_load_dwordx4 v[100:103], v9, s[48:51], s10 offen nt
  buffer_load_dwordx4 v[104:107], v10, s[48:51], s10 offen nt
  buffer_load_dwordx4 v[108:111], v11, s[48:51], s10 offen nt
  buffer_load_dwordx4 v[112:115], v12, s[48:51], s10 offen nt
  buffer_load_dwordx4 v[116:119], v13, s[48:51], s10 offen nt
  buffer_load_dwordx4 v[120:123], v14, s[48:51], s10 offen nt
  buffer_load_dwordx4 v[124:127], v15, s[48:51], s10 offen nt
  s_mov_b32 s10, 262144
  buffer_load_dwordx4 v[128:131], v8, s[48:51], s10 offen nt
  buffer_load_dwordx4 v[132:135], v9, s[48:51], s10 offen nt
  buffer_load_dwordx4 v[136:139], v10, s[48:51], s10 offen nt
  buffer_load_dwordx4 v[140:143], v11, s[48:51], s10 offen nt
  buffer_load_dwordx4 v[144:147], v12, s[48:51], s10 offen nt
  buffer_load_dwordx4 v[148:151], v13, s[48:51], s10 offen nt
  buffer_load_dwordx4 v[152:155], v14, s[48:51], s10 offen nt
  buffer_load_dwordx4 v[156:159], v15, s[48:51], s10 offen nt
  v_mov_b32 v8, v5
  v_add_u32 v9, 8192, v8
  v_add_u32 v10, 8192, v9
  v_add_u32 v11, 8192, v10
  v_add_u32 v12, 8192, v11
  v_add_u32 v13, 8192, v12
  v_add_u32 v14, 8192, v13
  v_add_u32 v15, 8192, v14
  s_mov_b32 s10, 524288
  buffer_load_dwordx4 v[160:163], v8, s[48:51], s10 offen nt
  buffer_load_dwordx4 v[164:167], v9, s[48:51], s10 offen nt
  buffer_load_dwordx4 v[168:171], v10, s[48:51], s10 offen nt
  buffer_load_dwordx4 v[172:175], v11, s[48:51], s10 offen nt
  buffer_load_dwordx4 v[176:179], v12, s[48:51], s10 offen nt
  buffer_load_dwordx4 v[180:183], v13, s[48:51], s10 offen nt
  buffer_load_dwordx4 v[184:187], v14, s[48:51], s10 offen nt
  buffer_load_dwordx4 v[188:191], v15, s[48:51], s10 offen nt
  s_waitcnt vmcnt(24)
  v_lshlrev_b32 v26, 16, v16
  v_and_b32 v27, 0xffff0000, v16
  v_lshlrev_b32 v28, 16, v17
  v_and_b32 v29, 0xffff0000, v17
  v_lshlrev_b32 v30, 16, v18
  v_and_b32 v31, 0xffff0000, v18
  v_lshlrev_b32 v32, 16, v19
  v_and_b32 v33, 0xffff0000, v19
  v_lshlrev_b32 v34, 16, v20
  v_and_b32 v35, 0xffff0000, v20
  v_lshlrev_b32 v36, 16, v21
  v_and_b32 v37, 0xffff0000, v21
  v_lshlrev_b32 v38, 16, v22
  v_and_b32 v39, 0xffff0000, v22
  v_lshlrev_b32 v40, 16, v23
  v_and_b32 v41, 0xffff0000, v23
  v_lshlrev_b32 v42, 16, v24
  v_and_b32 v43, 0xffff0000, v24
  v_lshlrev_b32 v44, 16, v25
  v_and_b32 v45, 0xffff0000, v25
  v_add_f32 v46, v26, v27
  v_add_f32 v47, v28, v29
  v_add_f32 v46, v46, v30
  v_add_f32 v47, v47, v31
  v_add_f32 v46, v46, v32
  v_add_f32 v47, v47, v33
  v_add_f32 v46, v46, v34
  v_add_f32 v47, v47, v35
  v_add_f32 v46, v46, v36
  v_add_f32 v47, v47, v37
  v_add_f32 v46, v46, v38
  v_add_f32 v47, v47, v39
  v_add_f32 v46, v46, v40
  v_add_f32 v47, v47, v41
  v_add_f32 v46, v46, v42
  v_add_f32 v47, v47, v43
  v_add_f32 v46, v46, v44
  v_add_f32 v47, v47, v45
  v_add_f32 v46, v46, v47
  s_nop 1
  v_add_f32_dpp v46, v46, v46 quad_perm:[1,0,3,2] row_mask:0xf bank_mask:0xf
  s_nop 1
  v_add_f32_dpp v46, v46, v46 quad_perm:[2,3,0,1] row_mask:0xf bank_mask:0xf
  s_nop 1
  v_add_f32_dpp v46, v46, v46 row_half_mirror row_mask:0xf bank_mask:0xf
  s_nop 1
  v_add_f32_dpp v46, v46, v46 row_mirror row_mask:0xf bank_mask:0xf
  v_mov_b32 v47, v46
  s_nop 1
  v_permlane16_swap_b32 v46, v47
  v_add_f32 v46, v46, v47
  v_mul_f32 v46, 0x3ae38e39, v46
  v_and_b32 v47, 16, v0
  v_cmp_eq_u32 vcc, 0, v47
  v_mov_b32 v48, 0
  v_mov_b32 v50, 0
  v_sub_f32 v49, v26, v46
  v_sub_f32 v51, v27, v46
  v_fmac_f32 v48, v49, v49
  v_fmac_f32 v50, v51, v51
  v_sub_f32 v49, v28, v46
  v_sub_f32 v51, v29, v46
  v_fmac_f32 v48, v49, v49
  v_fmac_f32 v50, v51, v51
  v_sub_f32 v49, v30, v46
  v_sub_f32 v51, v31, v46
  v_fmac_f32 v48, v49, v49
  v_fmac_f32 v50, v51, v51
  v_sub_f32 v49, v32, v46
  v_sub_f32 v51, v33, v46
  v_fmac_f32 v48, v49, v49
  v_fmac_f32 v50, v51, v51
  v_sub_f32 v49, v34, v46
  v_sub_f32 v51, v35, v46
  v_fmac_f32 v48, v49, v49
  v_fmac_f32 v50, v51, v51
  v_sub_f32 v49, v36, v46
  v_sub_f32 v51, v37, v46
  v_fmac_f32 v48, v49, v49
  v_fmac_f32 v50, v51, v51
  v_sub_f32 v49, v38, v46
  v_sub_f32 v51, v39, v46
  v_fmac_f32 v48, v49, v49
  v_fmac_f32 v50, v51, v51
  v_sub_f32 v49, v40, v46
  v_sub_f32 v51, v41, v46
  v_fmac_f32 v48, v49, v49
  v_fmac_f32 v50, v51, v51
  v_sub_f32 v49, v42, v46
  v_sub_f32 v51, v43, v46
  v_cndmask_b32 v49, 0, v49, vcc
  v_cndmask_b32 v51, 0, v51, vcc
  v_fmac_f32 v48, v49, v49
  v_fmac_f32 v50, v51, v51
  v_sub_f32 v49, v44, v46
  v_sub_f32 v51, v45, v46
  v_cndmask_b32 v49, 0, v49, vcc
  v_cndmask_b32 v51, 0, v51, vcc
  v_fmac_f32 v48, v49, v49
  v_fmac_f32 v50, v51, v51
  v_add_f32 v48, v48, v50
  s_nop 1
  v_add_f32_dpp v48, v48, v48 quad_perm:[1,0,3,2] row_mask:0xf bank_mask:0xf
  s_nop 1
  v_add_f32_dpp v48, v48, v48 quad_perm:[2,3,0,1] row_mask:0xf bank_mask:0xf
  s_nop 1
  v_add_f32_dpp v48, v48, v48 row_half_mirror row_mask:0xf bank_mask:0xf
  s_nop 1
  v_add_f32_dpp v48, v48, v48 row_mirror row_mask:0xf bank_mask:0xf
  v_mov_b32 v47, v48
  s_nop 1
  v_permlane16_swap_b32 v48, v47
  v_add_f32 v48, v48, v47
  v_mul_f32 v48, 0x3ae38e39, v48
  v_cvt_pk_bf16_f32 v47, v46, v48
  v_lshlrev_b32 v46, 16, v47
  v_and_b32 v48, 0xffff0000, v47
  v_add_f32 v48, 0x3727c5ac, v48
  v_cvt_pk_bf16_f32 v48, v48, v48
  v_lshlrev_b32 v48, 16, v48
  v_sqrt_f32 v48, v48
  s_nop 0
  v_cvt_pk_bf16_f32 v48, v48, v48
  v_lshlrev_b32 v48, 16, v48
  v_rcp_f32 v48, v48
  v_sub_f32 v50, v26, v46
  v_sub_f32 v51, v27, v46
  v_cvt_pk_bf16_f32 v50, v50, v51
  v_and_b32 v51, 0xffff0000, v50
  v_lshlrev_b32 v50, 16, v50
  v_mul_f32 v50, v50, v48
  v_mul_f32 v51, v51, v48
  v_cvt_pk_bf16_f32 v16, v50, v51
  v_sub_f32 v52, v28, v46
  v_sub_f32 v53, v29, v46
  v_cvt_pk_bf16_f32 v52, v52, v53
  v_and_b32 v53, 0xffff0000, v52
  v_lshlrev_b32 v52, 16, v52
  v_mul_f32 v52, v52, v48
  v_mul_f32 v53, v53, v48
  v_cvt_pk_bf16_f32 v17, v52, v53
  v_sub_f32 v50, v30, v46
  v_sub_f32 v51, v31, v46
  v_cvt_pk_bf16_f32 v50, v50, v51
  v_and_b32 v51, 0xffff0000, v50
  v_lshlrev_b32 v50, 16, v50
  v_mul_f32 v50, v50, v48
  v_mul_f32 v51, v51, v48
  v_cvt_pk_bf16_f32 v18, v50, v51
  v_sub_f32 v52, v32, v46
  v_sub_f32 v53, v33, v46
  v_cvt_pk_bf16_f32 v52, v52, v53
  v_and_b32 v53, 0xffff0000, v52
  v_lshlrev_b32 v52, 16, v52
  v_mul_f32 v52, v52, v48
  v_mul_f32 v53, v53, v48
  v_cvt_pk_bf16_f32 v19, v52, v53
  v_sub_f32 v50, v34, v46
  v_sub_f32 v51, v35, v46
  v_cvt_pk_bf16_f32 v50, v50, v51
  v_and_b32 v51, 0xffff0000, v50
  v_lshlrev_b32 v50, 16, v50
  v_mul_f32 v50, v50, v48
  v_mul_f32 v51, v51, v48
  v_cvt_pk_bf16_f32 v20, v50, v51
  v_sub_f32 v52, v36, v46
  v_sub_f32 v53, v37, v46
  v_cvt_pk_bf16_f32 v52, v52, v53
  v_and_b32 v53, 0xffff0000, v52
  v_lshlrev_b32 v52, 16, v52
  v_mul_f32 v52, v52, v48
  v_mul_f32 v53, v53, v48
  v_cvt_pk_bf16_f32 v21, v52, v53
  v_sub_f32 v50, v38, v46
  v_sub_f32 v51, v39, v46
  v_cvt_pk_bf16_f32 v50, v50, v51
  v_and_b32 v51, 0xffff0000, v50
  v_lshlrev_b32 v50, 16, v50
  v_mul_f32 v50, v50, v48
  v_mul_f32 v51, v51, v48
  v_cvt_pk_bf16_f32 v22, v50, v51
  v_sub_f32 v52, v40, v46
  v_sub_f32 v53, v41, v46
  v_cvt_pk_bf16_f32 v52, v52, v53
  v_and_b32 v53, 0xffff0000, v52
  v_lshlrev_b32 v52, 16, v52
  v_mul_f32 v52, v52, v48
  v_mul_f32 v53, v53, v48
  v_cvt_pk_bf16_f32 v23, v52, v53
  v_sub_f32 v50, v42, v46
  v_sub_f32 v51, v43, v46
  v_cvt_pk_bf16_f32 v50, v50, v51
  v_and_b32 v51, 0xffff0000, v50
  v_lshlrev_b32 v50, 16, v50
  v_mul_f32 v50, v50, v48
  v_mul_f32 v51, v51, v48
  v_cvt_pk_bf16_f32 v24, v50, v51
  v_sub_f32 v52, v44, v46
  v_sub_f32 v53, v45, v46
  v_cvt_pk_bf16_f32 v52, v52, v53
  v_and_b32 v53, 0xffff0000, v52
  v_lshlrev_b32 v52, 16, v52
  v_mul_f32 v52, v52, v48
  v_mul_f32 v53, v53, v48
  v_cvt_pk_bf16_f32 v25, v52, v53
  s_mul_i32 s13, s3, 3072
  s_add_u32 s13, s13, 11520
  v_lshrrev_b32 v52, 5, v0
  v_mul_u32_u24 v52, 1536, v52
  v_and_b32 v53, 31, v0
  v_lshl_add_u32 v52, v53, 3, v52
  v_add_u32 v52, s13, v52
  ds_write_b64 v52, v[16:17] offset:0
  ds_write_b64 v52, v[18:19] offset:256
  ds_write_b64 v52, v[20:21] offset:512
  ds_write_b64 v52, v[22:23] offset:768
  ds_write_b64 v52, v[24:25] offset:1024
  v_and_b32 v52, 1, v2
  v_mul_u32_u24 v52, 1536, v52
  v_bfe_u32 v53, v2, 1, 1
  v_mul_u32_u24 v53, 144, v53
  v_add_u32 v52, v52, v53
  v_lshl_add_u32 v52, v3, 4, v52
  s_mul_i32 s9, s15, 288
  s_add_u32 s9, s9, s13
  v_add_u32 v52, s9, v52
  s_waitcnt lgkmcnt(0)
  ds_read_b128 v[16:19], v52 offset:0
  ds_read_b128 v[20:23], v52 offset:64
  ds_read_b128 v[24:27], v52 offset:128
  s_waitcnt lgkmcnt(0)
  s_waitcnt vmcnt(16)
  v_perm_b32 v48, v100, v96, s59
  v_perm_b32 v49, v108, v104, s59
  v_perm_b32 v50, v116, v112, s59
  v_perm_b32 v51, v124, v120, s59
  v_perm_b32 v52, v100, v96, s60
  v_perm_b32 v53, v108, v104, s60
  v_perm_b32 v54, v116, v112, s60
  v_perm_b32 v55, v124, v120, s60
  v_mfma_f32_16x16x32_bf16 v[64:67], v[16:19], v[48:51], 0
  s_nop 0
  v_mfma_f32_16x16x32_bf16 v[68:71], v[16:19], v[52:55], 0
  v_perm_b32 v56, v101, v97, s59
  v_perm_b32 v57, v109, v105, s59
  v_perm_b32 v58, v117, v113, s59
  v_perm_b32 v59, v125, v121, s59
  v_perm_b32 v60, v101, v97, s60
  v_perm_b32 v61, v109, v105, s60
  v_perm_b32 v62, v117, v113, s60
  v_perm_b32 v63, v125, v121, s60
  v_mfma_f32_16x16x32_bf16 v[72:75], v[16:19], v[56:59], 0
  s_nop 0
  v_mfma_f32_16x16x32_bf16 v[76:79], v[16:19], v[60:63], 0
  v_perm_b32 v48, v102, v98, s59
  v_perm_b32 v49, v110, v106, s59
  v_perm_b32 v50, v118, v114, s59
  v_perm_b32 v51, v126, v122, s59
  v_perm_b32 v52, v102, v98, s60
  v_perm_b32 v53, v110, v106, s60
  v_perm_b32 v54, v118, v114, s60
  v_perm_b32 v55, v126, v122, s60
  v_mfma_f32_16x16x32_bf16 v[80:83], v[16:19], v[48:51], 0
  s_nop 0
  v_mfma_f32_16x16x32_bf16 v[84:87], v[16:19], v[52:55], 0
  v_perm_b32 v56, v103, v99, s59
  v_perm_b32 v57, v111, v107, s59
  v_perm_b32 v58, v119, v115, s59
  v_perm_b32 v59, v127, v123, s59
  v_perm_b32 v60, v103, v99, s60
  v_perm_b32 v61, v111, v107, s60
  v_perm_b32 v62, v119, v115, s60
  v_perm_b32 v63, v127, v123, s60
  v_mfma_f32_16x16x32_bf16 v[88:91], v[16:19], v[56:59], 0
  s_nop 0
  v_mfma_f32_16x16x32_bf16 v[92:95], v[16:19], v[60:63], 0
  s_waitcnt vmcnt(8)
  v_perm_b32 v48, v132, v128, s59
  v_perm_b32 v49, v140, v136, s59
  v_perm_b32 v50, v148, v144, s59
  v_perm_b32 v51, v156, v152, s59
  v_perm_b32 v52, v132, v128, s60
  v_perm_b32 v53, v140, v136, s60
  v_perm_b32 v54, v148, v144, s60
  v_perm_b32 v55, v156, v152, s60
  v_mfma_f32_16x16x32_bf16 v[64:67], v[20:23], v[48:51], v[64:67]
  s_nop 0
  v_mfma_f32_16x16x32_bf16 v[68:71], v[20:23], v[52:55], v[68:71]
  v_perm_b32 v56, v133, v129, s59
  v_perm_b32 v57, v141, v137, s59
  v_perm_b32 v58, v149, v145, s59
  v_perm_b32 v59, v157, v153, s59
  v_perm_b32 v60, v133, v129, s60
  v_perm_b32 v61, v141, v137, s60
  v_perm_b32 v62, v149, v145, s60
  v_perm_b32 v63, v157, v153, s60
  v_mfma_f32_16x16x32_bf16 v[72:75], v[20:23], v[56:59], v[72:75]
  s_nop 0
  v_mfma_f32_16x16x32_bf16 v[76:79], v[20:23], v[60:63], v[76:79]
  v_perm_b32 v48, v134, v130, s59
  v_perm_b32 v49, v142, v138, s59
  v_perm_b32 v50, v150, v146, s59
  v_perm_b32 v51, v158, v154, s59
  v_perm_b32 v52, v134, v130, s60
  v_perm_b32 v53, v142, v138, s60
  v_perm_b32 v54, v150, v146, s60
  v_perm_b32 v55, v158, v154, s60
  v_mfma_f32_16x16x32_bf16 v[80:83], v[20:23], v[48:51], v[80:83]
  s_nop 0
  v_mfma_f32_16x16x32_bf16 v[84:87], v[20:23], v[52:55], v[84:87]
  v_perm_b32 v56, v135, v131, s59
  v_perm_b32 v57, v143, v139, s59
  v_perm_b32 v58, v151, v147, s59
  v_perm_b32 v59, v159, v155, s59
  v_perm_b32 v60, v135, v131, s60
  v_perm_b32 v61, v143, v139, s60
  v_perm_b32 v62, v151, v147, s60
  v_perm_b32 v63, v159, v155, s60
  v_mfma_f32_16x16x32_bf16 v[88:91], v[20:23], v[56:59], v[88:91]
  s_nop 0
  v_mfma_f32_16x16x32_bf16 v[92:95], v[20:23], v[60:63], v[92:95]
  s_waitcnt vmcnt(0)
  s_barrier
  v_perm_b32 v48, v164, v160, s59
  v_perm_b32 v49, v172, v168, s59
  v_perm_b32 v50, v180, v176, s59
  v_perm_b32 v51, v188, v184, s59
  v_perm_b32 v52, v164, v160, s60
  v_perm_b32 v53, v172, v168, s60
  v_perm_b32 v54, v180, v176, s60
  v_perm_b32 v55, v188, v184, s60
  v_mfma_f32_16x16x32_bf16 v[64:67], v[24:27], v[48:51], v[64:67]
  s_nop 0
  v_mfma_f32_16x16x32_bf16 v[68:71], v[24:27], v[52:55], v[68:71]
  v_perm_b32 v56, v165, v161, s59
  v_perm_b32 v57, v173, v169, s59
  v_perm_b32 v58, v181, v177, s59
  v_perm_b32 v59, v189, v185, s59
  v_perm_b32 v60, v165, v161, s60
  v_perm_b32 v61, v173, v169, s60
  v_perm_b32 v62, v181, v177, s60
  v_perm_b32 v63, v189, v185, s60
  v_mfma_f32_16x16x32_bf16 v[72:75], v[24:27], v[56:59], v[72:75]
  s_nop 0
  v_mfma_f32_16x16x32_bf16 v[76:79], v[24:27], v[60:63], v[76:79]
  v_perm_b32 v48, v166, v162, s59
  v_perm_b32 v49, v174, v170, s59
  v_perm_b32 v50, v182, v178, s59
  v_perm_b32 v51, v190, v186, s59
  v_perm_b32 v52, v166, v162, s60
  v_perm_b32 v53, v174, v170, s60
  v_perm_b32 v54, v182, v178, s60
  v_perm_b32 v55, v190, v186, s60
  v_mfma_f32_16x16x32_bf16 v[80:83], v[24:27], v[48:51], v[80:83]
  s_nop 0
  v_mfma_f32_16x16x32_bf16 v[84:87], v[24:27], v[52:55], v[84:87]
  v_perm_b32 v56, v167, v163, s59
  v_perm_b32 v57, v175, v171, s59
  v_perm_b32 v58, v183, v179, s59
  v_perm_b32 v59, v191, v187, s59
  v_perm_b32 v60, v167, v163, s60
  v_perm_b32 v61, v175, v171, s60
  v_perm_b32 v62, v183, v179, s60
  v_perm_b32 v63, v191, v187, s60
  v_mfma_f32_16x16x32_bf16 v[88:91], v[24:27], v[56:59], v[88:91]
  s_nop 0
  v_mfma_f32_16x16x32_bf16 v[92:95], v[24:27], v[60:63], v[92:95]
  v_and_b32 v32, 8, v2
  v_cmp_ne_u32 vcc, 0, v32
  s_nop 1
  v_cndmask_b32 v16, v64, v66, vcc
  v_cndmask_b32 v17, v68, v70, vcc
  v_cndmask_b32 v18, v72, v74, vcc
  v_cndmask_b32 v19, v76, v78, vcc
  v_cndmask_b32 v20, v80, v82, vcc
  v_cndmask_b32 v21, v84, v86, vcc
  v_cndmask_b32 v22, v88, v90, vcc
  v_cndmask_b32 v23, v92, v94, vcc
  v_cndmask_b32 v24, v65, v67, vcc
  v_cndmask_b32 v25, v69, v71, vcc
  v_cndmask_b32 v26, v73, v75, vcc
  v_cndmask_b32 v27, v77, v79, vcc
  v_cndmask_b32 v28, v81, v83, vcc
  v_cndmask_b32 v29, v85, v87, vcc
  v_cndmask_b32 v30, v89, v91, vcc
  v_cndmask_b32 v31, v93, v95, vcc
  v_add_f32_dpp v16, v16, v16 row_ror:8 row_mask:0xf bank_mask:0xf
  v_add_f32_dpp v17, v17, v17 row_ror:8 row_mask:0xf bank_mask:0xf
  v_add_f32_dpp v18, v18, v18 row_ror:8 row_mask:0xf bank_mask:0xf
  v_add_f32_dpp v19, v19, v19 row_ror:8 row_mask:0xf bank_mask:0xf
  v_add_f32_dpp v20, v20, v20 row_ror:8 row_mask:0xf bank_mask:0xf
  v_add_f32_dpp v21, v21, v21 row_ror:8 row_mask:0xf bank_mask:0xf
  v_add_f32_dpp v22, v22, v22 row_ror:8 row_mask:0xf bank_mask:0xf
  v_add_f32_dpp v23, v23, v23 row_ror:8 row_mask:0xf bank_mask:0xf
  v_add_f32_dpp v24, v24, v24 row_ror:8 row_mask:0xf bank_mask:0xf
  v_add_f32_dpp v25, v25, v25 row_ror:8 row_mask:0xf bank_mask:0xf
  v_add_f32_dpp v26, v26, v26 row_ror:8 row_mask:0xf bank_mask:0xf
  v_add_f32_dpp v27, v27, v27 row_ror:8 row_mask:0xf bank_mask:0xf
  v_add_f32_dpp v28, v28, v28 row_ror:8 row_mask:0xf bank_mask:0xf
  v_add_f32_dpp v29, v29, v29 row_ror:8 row_mask:0xf bank_mask:0xf
  v_add_f32_dpp v30, v30, v30 row_ror:8 row_mask:0xf bank_mask:0xf
  v_add_f32_dpp v31, v31, v31 row_ror:8 row_mask:0xf bank_mask:0xf
  v_min_u32 v16, -2, v16
  v_min_u32 v17, -2, v17
  v_min_u32 v18, -2, v18
  v_min_u32 v19, -2, v19
  v_min_u32 v20, -2, v20
  v_min_u32 v21, -2, v21
  v_min_u32 v22, -2, v22
  v_min_u32 v23, -2, v23
  v_min_u32 v24, -2, v24
  v_min_u32 v25, -2, v25
  v_min_u32 v26, -2, v26
  v_min_u32 v27, -2, v27
  v_min_u32 v28, -2, v28
  v_min_u32 v29, -2, v29
  v_min_u32 v30, -2, v30
  v_min_u32 v31, -2, v31
  s_mov_b32 s12, 65536
  s_nop 0
L_rst1_poll:
  v_mov_b32 v33, 512
  ds_read_b32 v34, v33
  s_waitcnt lgkmcnt(0)
  v_readfirstlane_b32 s8, v34
  s_nop 0
  s_cmp_eq_u32 s8, 1
  s_nop 2
  s_cbranch_scc1 L_rst1_ok
  s_sleep 1
  s_sub_u32 s12, s12, 1
  s_cmp_lg_u32 s12, 0
  s_cbranch_scc1 L_rst1_poll
L_rst1_ok:
  s_and_b32 s8, s62, 3
  s_lshl_b32 s8, s8, 8
  s_lshl_b32 s9, s15, 10
  s_add_u32 s8, s8, s9
  s_lshl_b32 s9, s4, 13
  s_add_u32 s8, s8, s9
  s_add_u32 s8, s8, 294912
  s_add_u32 s9, s8, 4096
  v_lshlrev_b32 v32, 5, v2
  s_mov_b64 exec, 0xff
  buffer_store_dwordx4 v[16:19], v32, s[52:55], s8 offen sc0 sc1
  buffer_store_dwordx4 v[20:23], v32, s[52:55], s8 offen offset:16 sc0 sc1
  buffer_store_dwordx4 v[24:27], v32, s[52:55], s9 offen sc0 sc1
  buffer_store_dwordx4 v[28:31], v32, s[52:55], s9 offen offset:16 sc0 sc1
  s_mov_b64 exec, -1
  s_barrier
  s_branch L_aux2
L_aux23:
  s_mov_b32 s71, 0
  s_cmp_eq_u32 s3, 2
  s_cbranch_scc0 L_aux3sel
  s_cmp_lt_u32 s61, 7
  s_cselect_b32 s71, 1, 0
  s_branch L_auxsel_done
L_aux3sel:
  s_mov_b32 s64, s65
  s_cmp_lt_u32 s61, 2
  s_cselect_b32 s71, 1, 0
L_auxsel_done:
  s_cmp_ge_u32 s64, 72
  s_cselect_b32 s15, 1, 0
  s_cmp_ge_u32 s64, 144
  s_cselect_b32 s15, 2, s15
  s_cmp_ge_u32 s64, 216
  s_cselect_b32 s15, 3, s15
  s_mul_i32 s70, s15, 72
  s_sub_u32 s70, s64, s70
  s_mul_i32 s8, s15, 1327104
  s_lshl_b32 s9, s70, 7
  s_add_u32 s8, s8, s9
  v_lshrrev_b32 v6, 5, v0
  v_mul_u32_u24 v6, 1152, v6
  v_and_b32 v7, 31, v0
  v_lshl_add_u32 v6, v7, 3, v6
  v_add_u32 v7, 0x400, v6
  v_and_b32 v8, 16, v0
  v_cmp_eq_u32 vcc, 0, v8
  v_mov_b32 v9, 0x40000000
  s_nop 0
  v_cndmask_b32 v7, v9, v7, vcc
  v_lshrrev_b32 v8, 3, v2
  v_mul_u32_u24 v8, 72, v8
  v_lshl_add_u32 v8, v3, 3, v8
  v_mul_u32_u24 v8, 9216, v8
  v_and_b32 v10, 7, v2
  v_lshl_add_u32 v8, v10, 4, v8
  v_add_u32 v8, s8, v8
  v_cmp_gt_u32 vcc, 16, v0
  s_nop 1
  v_cndmask_b32 v5, v9, v8, vcc
  s_mov_b32 s46, 2304
  s_mov_b32 s47, 0x20000
  s_mov_b32 s50, 5308416
  s_cmp_eq_u32 s71, 0
  s_cselect_b32 s50, 0, s50
  s_cselect_b32 s46, 0, s46
  s_mov_b32 s51, 0x20000
  s_mov_b32 s54, 0x40000000
  s_mov_b32 s55, 0x20000
  s_waitcnt lgkmcnt(0)
  s_mov_b32 s44, s16
  s_mov_b32 s45, s17
  s_mov_b32 s48, s28
  s_mov_b32 s49, s29
  s_mov_b32 s52, s40
  s_mov_b32 s53, s41
  s_barrier
  buffer_load_dwordx2 v[16:17], v6, s[44:47], 0 offen offset:0
  buffer_load_dwordx2 v[18:19], v6, s[44:47], 0 offen offset:256
  buffer_load_dwordx2 v[20:21], v6, s[44:47], 0 offen offset:512
  buffer_load_dwordx2 v[22:23], v6, s[44:47], 0 offen offset:768
  buffer_load_dwordx2 v[24:25], v7, s[44:47], 0 offen
  v_add_u32 v9, 9216, v8
  v_add_u32 v10, 9216, v9
  v_add_u32 v11, 9216, v10
  v_add_u32 v12, 9216, v11
  v_add_u32 v13, 9216, v12
  v_add_u32 v14, 9216, v13
  v_add_u32 v15, 9216, v14
  s_mov_b32 s10, 0
  buffer_load_dwordx4 v[96:99], v8, s[48:51], s10 offen nt
  buffer_load_dwordx4 v[100:103], v9, s[48:51], s10 offen nt
  buffer_load_dwordx4 v[104:107], v10, s[48:51], s10 offen nt
  buffer_load_dwordx4 v[108:111], v11, s[48:51], s10 offen nt
  buffer_load_dwordx4 v[112:115], v12, s[48:51], s10 offen nt
  buffer_load_dwordx4 v[116:119], v13, s[48:51], s10 offen nt
  buffer_load_dwordx4 v[120:123], v14, s[48:51], s10 offen nt
  buffer_load_dwordx4 v[124:127], v15, s[48:51], s10 offen nt
  s_mov_b32 s10, 294912
  buffer_load_dwordx4 v[128:131], v8, s[48:51], s10 offen nt
  buffer_load_dwordx4 v[132:135], v9, s[48:51], s10 offen nt
  buffer_load_dwordx4 v[136:139], v10, s[48:51], s10 offen nt
  buffer_load_dwordx4 v[140:143], v11, s[48:51], s10 offen nt
  buffer_load_dwordx4 v[144:147], v12, s[48:51], s10 offen nt
  buffer_load_dwordx4 v[148:151], v13, s[48:51], s10 offen nt
  buffer_load_dwordx4 v[152:155], v14, s[48:51], s10 offen nt
  buffer_load_dwordx4 v[156:159], v15, s[48:51], s10 offen nt
  v_mov_b32 v8, v5
  v_add_u32 v9, 9216, v8
  v_add_u32 v10, 9216, v9
  v_add_u32 v11, 9216, v10
  v_add_u32 v12, 9216, v11
  v_add_u32 v13, 9216, v12
  v_add_u32 v14, 9216, v13
  v_add_u32 v15, 9216, v14
  s_mov_b32 s10, 589824
  buffer_load_dwordx4 v[160:163], v8, s[48:51], s10 offen nt
  buffer_load_dwordx4 v[164:167], v9, s[48:51], s10 offen nt
  buffer_load_dwordx4 v[168:171], v10, s[48:51], s10 offen nt
  buffer_load_dwordx4 v[172:175], v11, s[48:51], s10 offen nt
  buffer_load_dwordx4 v[176:179], v12, s[48:51], s10 offen nt
  buffer_load_dwordx4 v[180:183], v13, s[48:51], s10 offen nt
  buffer_load_dwordx4 v[184:187], v14, s[48:51], s10 offen nt
  buffer_load_dwordx4 v[188:191], v15, s[48:51], s10 offen nt
  s_barrier
  s_barrier
  s_cmp_eq_u32 s71, 0
  s_cbranch_scc1 L_aux2
  s_waitcnt vmcnt(24)
  v_lshlrev_b32 v26, 16, v16
  v_and_b32 v27, 0xffff0000, v16
  v_lshlrev_b32 v28, 16, v17
  v_and_b32 v29, 0xffff0000, v17
  v_lshlrev_b32 v30, 16, v18
  v_and_b32 v31, 0xffff0000, v18
  v_lshlrev_b32 v32, 16, v19
  v_and_b32 v33, 0xffff0000, v19
  v_lshlrev_b32 v34, 16, v20
  v_and_b32 v35, 0xffff0000, v20
  v_lshlrev_b32 v36, 16, v21
  v_and_b32 v37, 0xffff0000, v21
  v_lshlrev_b32 v38, 16, v22
  v_and_b32 v39, 0xffff0000, v22
  v_lshlrev_b32 v40, 16, v23
  v_and_b32 v41, 0xffff0000, v23
  v_lshlrev_b32 v42, 16, v24
  v_and_b32 v43, 0xffff0000, v24
  v_lshlrev_b32 v44, 16, v25
  v_and_b32 v45, 0xffff0000, v25
  v_add_f32 v46, v26, v27
  v_add_f32 v47, v28, v29
  v_add_f32 v46, v46, v30
  v_add_f32 v47, v47, v31
  v_add_f32 v46, v46, v32
  v_add_f32 v47, v47, v33
  v_add_f32 v46, v46, v34
  v_add_f32 v47, v47, v35
  v_add_f32 v46, v46, v36
  v_add_f32 v47, v47, v37
  v_add_f32 v46, v46, v38
  v_add_f32 v47, v47, v39
  v_add_f32 v46, v46, v40
  v_add_f32 v47, v47, v41
  v_add_f32 v46, v46, v42
  v_add_f32 v47, v47, v43
  v_add_f32 v46, v46, v44
  v_add_f32 v47, v47, v45
  v_add_f32 v46, v46, v47
  s_nop 1
  v_add_f32_dpp v46, v46, v46 quad_perm:[1,0,3,2] row_mask:0xf bank_mask:0xf
  s_nop 1
  v_add_f32_dpp v46, v46, v46 quad_perm:[2,3,0,1] row_mask:0xf bank_mask:0xf
  s_nop 1
  v_add_f32_dpp v46, v46, v46 row_half_mirror row_mask:0xf bank_mask:0xf
  s_nop 1
  v_add_f32_dpp v46, v46, v46 row_mirror row_mask:0xf bank_mask:0xf
  v_mov_b32 v47, v46
  s_nop 1
  v_permlane16_swap_b32 v46, v47
  v_add_f32 v46, v46, v47
  v_mul_f32 v46, 0x3ae38e39, v46
  v_and_b32 v47, 16, v0
  v_cmp_eq_u32 vcc, 0, v47
  v_mov_b32 v48, 0
  v_mov_b32 v50, 0
  v_sub_f32 v49, v26, v46
  v_sub_f32 v51, v27, v46
  v_fmac_f32 v48, v49, v49
  v_fmac_f32 v50, v51, v51
  v_sub_f32 v49, v28, v46
  v_sub_f32 v51, v29, v46
  v_fmac_f32 v48, v49, v49
  v_fmac_f32 v50, v51, v51
  v_sub_f32 v49, v30, v46
  v_sub_f32 v51, v31, v46
  v_fmac_f32 v48, v49, v49
  v_fmac_f32 v50, v51, v51
  v_sub_f32 v49, v32, v46
  v_sub_f32 v51, v33, v46
  v_fmac_f32 v48, v49, v49
  v_fmac_f32 v50, v51, v51
  v_sub_f32 v49, v34, v46
  v_sub_f32 v51, v35, v46
  v_fmac_f32 v48, v49, v49
  v_fmac_f32 v50, v51, v51
  v_sub_f32 v49, v36, v46
  v_sub_f32 v51, v37, v46
  v_fmac_f32 v48, v49, v49
  v_fmac_f32 v50, v51, v51
  v_sub_f32 v49, v38, v46
  v_sub_f32 v51, v39, v46
  v_fmac_f32 v48, v49, v49
  v_fmac_f32 v50, v51, v51
  v_sub_f32 v49, v40, v46
  v_sub_f32 v51, v41, v46
  v_fmac_f32 v48, v49, v49
  v_fmac_f32 v50, v51, v51
  v_sub_f32 v49, v42, v46
  v_sub_f32 v51, v43, v46
  v_cndmask_b32 v49, 0, v49, vcc
  v_cndmask_b32 v51, 0, v51, vcc
  v_fmac_f32 v48, v49, v49
  v_fmac_f32 v50, v51, v51
  v_sub_f32 v49, v44, v46
  v_sub_f32 v51, v45, v46
  v_cndmask_b32 v49, 0, v49, vcc
  v_cndmask_b32 v51, 0, v51, vcc
  v_fmac_f32 v48, v49, v49
  v_fmac_f32 v50, v51, v51
  v_add_f32 v48, v48, v50
  s_nop 1
  v_add_f32_dpp v48, v48, v48 quad_perm:[1,0,3,2] row_mask:0xf bank_mask:0xf
  s_nop 1
  v_add_f32_dpp v48, v48, v48 quad_perm:[2,3,0,1] row_mask:0xf bank_mask:0xf
  s_nop 1
  v_add_f32_dpp v48, v48, v48 row_half_mirror row_mask:0xf bank_mask:0xf
  s_nop 1
  v_add_f32_dpp v48, v48, v48 row_mirror row_mask:0xf bank_mask:0xf
  v_mov_b32 v47, v48
  s_nop 1
  v_permlane16_swap_b32 v48, v47
  v_add_f32 v48, v48, v47
  v_mul_f32 v48, 0x3ae38e39, v48
  v_cvt_pk_bf16_f32 v47, v46, v48
  v_lshlrev_b32 v46, 16, v47
  v_and_b32 v48, 0xffff0000, v47
  v_add_f32 v48, 0x3727c5ac, v48
  v_cvt_pk_bf16_f32 v48, v48, v48
  v_lshlrev_b32 v48, 16, v48
  v_sqrt_f32 v48, v48
  s_nop 0
  v_cvt_pk_bf16_f32 v48, v48, v48
  v_lshlrev_b32 v48, 16, v48
  v_rcp_f32 v48, v48
  v_sub_f32 v50, v26, v46
  v_sub_f32 v51, v27, v46
  v_cvt_pk_bf16_f32 v50, v50, v51
  v_and_b32 v51, 0xffff0000, v50
  v_lshlrev_b32 v50, 16, v50
  v_mul_f32 v50, v50, v48
  v_mul_f32 v51, v51, v48
  v_cvt_pk_bf16_f32 v16, v50, v51
  v_sub_f32 v52, v28, v46
  v_sub_f32 v53, v29, v46
  v_cvt_pk_bf16_f32 v52, v52, v53
  v_and_b32 v53, 0xffff0000, v52
  v_lshlrev_b32 v52, 16, v52
  v_mul_f32 v52, v52, v48
  v_mul_f32 v53, v53, v48
  v_cvt_pk_bf16_f32 v17, v52, v53
  v_sub_f32 v50, v30, v46
  v_sub_f32 v51, v31, v46
  v_cvt_pk_bf16_f32 v50, v50, v51
  v_and_b32 v51, 0xffff0000, v50
  v_lshlrev_b32 v50, 16, v50
  v_mul_f32 v50, v50, v48
  v_mul_f32 v51, v51, v48
  v_cvt_pk_bf16_f32 v18, v50, v51
  v_sub_f32 v52, v32, v46
  v_sub_f32 v53, v33, v46
  v_cvt_pk_bf16_f32 v52, v52, v53
  v_and_b32 v53, 0xffff0000, v52
  v_lshlrev_b32 v52, 16, v52
  v_mul_f32 v52, v52, v48
  v_mul_f32 v53, v53, v48
  v_cvt_pk_bf16_f32 v19, v52, v53
  v_sub_f32 v50, v34, v46
  v_sub_f32 v51, v35, v46
  v_cvt_pk_bf16_f32 v50, v50, v51
  v_and_b32 v51, 0xffff0000, v50
  v_lshlrev_b32 v50, 16, v50
  v_mul_f32 v50, v50, v48
  v_mul_f32 v51, v51, v48
  v_cvt_pk_bf16_f32 v20, v50, v51
  v_sub_f32 v52, v36, v46
  v_sub_f32 v53, v37, v46
  v_cvt_pk_bf16_f32 v52, v52, v53
  v_and_b32 v53, 0xffff0000, v52
  v_lshlrev_b32 v52, 16, v52
  v_mul_f32 v52, v52, v48
  v_mul_f32 v53, v53, v48
  v_cvt_pk_bf16_f32 v21, v52, v53
  v_sub_f32 v50, v38, v46
  v_sub_f32 v51, v39, v46
  v_cvt_pk_bf16_f32 v50, v50, v51
  v_and_b32 v51, 0xffff0000, v50
  v_lshlrev_b32 v50, 16, v50
  v_mul_f32 v50, v50, v48
  v_mul_f32 v51, v51, v48
  v_cvt_pk_bf16_f32 v22, v50, v51
  v_sub_f32 v52, v40, v46
  v_sub_f32 v53, v41, v46
  v_cvt_pk_bf16_f32 v52, v52, v53
  v_and_b32 v53, 0xffff0000, v52
  v_lshlrev_b32 v52, 16, v52
  v_mul_f32 v52, v52, v48
  v_mul_f32 v53, v53, v48
  v_cvt_pk_bf16_f32 v23, v52, v53
  v_sub_f32 v50, v42, v46
  v_sub_f32 v51, v43, v46
  v_cvt_pk_bf16_f32 v50, v50, v51
  v_and_b32 v51, 0xffff0000, v50
  v_lshlrev_b32 v50, 16, v50
  v_mul_f32 v50, v50, v48
  v_mul_f32 v51, v51, v48
  v_cvt_pk_bf16_f32 v24, v50, v51
  v_sub_f32 v52, v44, v46
  v_sub_f32 v53, v45, v46
  v_cvt_pk_bf16_f32 v52, v52, v53
  v_and_b32 v53, 0xffff0000, v52
  v_lshlrev_b32 v52, 16, v52
  v_mul_f32 v52, v52, v48
  v_mul_f32 v53, v53, v48
  v_cvt_pk_bf16_f32 v25, v52, v53
  s_mul_i32 s13, s3, 3072
  s_add_u32 s13, s13, 11520
  v_lshrrev_b32 v52, 5, v0
  v_mul_u32_u24 v52, 1536, v52
  v_and_b32 v53, 31, v0
  v_lshl_add_u32 v52, v53, 3, v52
  v_add_u32 v52, s13, v52
  ds_write_b64 v52, v[16:17] offset:0
  ds_write_b64 v52, v[18:19] offset:256
  ds_write_b64 v52, v[20:21] offset:512
  ds_write_b64 v52, v[22:23] offset:768
  ds_write_b64 v52, v[24:25] offset:1024
  v_and_b32 v52, 1, v2
  v_mul_u32_u24 v52, 1536, v52
  v_bfe_u32 v53, v2, 1, 1
  v_mul_u32_u24 v53, 144, v53
  v_add_u32 v52, v52, v53
  v_lshl_add_u32 v52, v3, 4, v52
  s_mul_i32 s9, s15, 288
  s_add_u32 s9, s9, s13
  v_add_u32 v52, s9, v52
  s_waitcnt lgkmcnt(0)
  ds_read_b128 v[16:19], v52 offset:0
  ds_read_b128 v[20:23], v52 offset:64
  ds_read_b128 v[24:27], v52 offset:128
  s_waitcnt lgkmcnt(0)
  s_waitcnt vmcnt(16)
  v_perm_b32 v48, v100, v96, s59
  v_perm_b32 v49, v108, v104, s59
  v_perm_b32 v50, v116, v112, s59
  v_perm_b32 v51, v124, v120, s59
  v_perm_b32 v52, v100, v96, s60
  v_perm_b32 v53, v108, v104, s60
  v_perm_b32 v54, v116, v112, s60
  v_perm_b32 v55, v124, v120, s60
  v_mfma_f32_16x16x32_bf16 v[64:67], v[16:19], v[48:51], 0
  s_nop 0
  v_mfma_f32_16x16x32_bf16 v[68:71], v[16:19], v[52:55], 0
  v_perm_b32 v56, v101, v97, s59
  v_perm_b32 v57, v109, v105, s59
  v_perm_b32 v58, v117, v113, s59
  v_perm_b32 v59, v125, v121, s59
  v_perm_b32 v60, v101, v97, s60
  v_perm_b32 v61, v109, v105, s60
  v_perm_b32 v62, v117, v113, s60
  v_perm_b32 v63, v125, v121, s60
  v_mfma_f32_16x16x32_bf16 v[72:75], v[16:19], v[56:59], 0
  s_nop 0
  v_mfma_f32_16x16x32_bf16 v[76:79], v[16:19], v[60:63], 0
  v_perm_b32 v48, v102, v98, s59
  v_perm_b32 v49, v110, v106, s59
  v_perm_b32 v50, v118, v114, s59
  v_perm_b32 v51, v126, v122, s59
  v_perm_b32 v52, v102, v98, s60
  v_perm_b32 v53, v110, v106, s60
  v_perm_b32 v54, v118, v114, s60
  v_perm_b32 v55, v126, v122, s60
  v_mfma_f32_16x16x32_bf16 v[80:83], v[16:19], v[48:51], 0
  s_nop 0
  v_mfma_f32_16x16x32_bf16 v[84:87], v[16:19], v[52:55], 0
  v_perm_b32 v56, v103, v99, s59
  v_perm_b32 v57, v111, v107, s59
  v_perm_b32 v58, v119, v115, s59
  v_perm_b32 v59, v127, v123, s59
  v_perm_b32 v60, v103, v99, s60
  v_perm_b32 v61, v111, v107, s60
  v_perm_b32 v62, v119, v115, s60
  v_perm_b32 v63, v127, v123, s60
  v_mfma_f32_16x16x32_bf16 v[88:91], v[16:19], v[56:59], 0
  s_nop 0
  v_mfma_f32_16x16x32_bf16 v[92:95], v[16:19], v[60:63], 0
  s_waitcnt vmcnt(8)
  v_perm_b32 v48, v132, v128, s59
  v_perm_b32 v49, v140, v136, s59
  v_perm_b32 v50, v148, v144, s59
  v_perm_b32 v51, v156, v152, s59
  v_perm_b32 v52, v132, v128, s60
  v_perm_b32 v53, v140, v136, s60
  v_perm_b32 v54, v148, v144, s60
  v_perm_b32 v55, v156, v152, s60
  v_mfma_f32_16x16x32_bf16 v[64:67], v[20:23], v[48:51], v[64:67]
  s_nop 0
  v_mfma_f32_16x16x32_bf16 v[68:71], v[20:23], v[52:55], v[68:71]
  v_perm_b32 v56, v133, v129, s59
  v_perm_b32 v57, v141, v137, s59
  v_perm_b32 v58, v149, v145, s59
  v_perm_b32 v59, v157, v153, s59
  v_perm_b32 v60, v133, v129, s60
  v_perm_b32 v61, v141, v137, s60
  v_perm_b32 v62, v149, v145, s60
  v_perm_b32 v63, v157, v153, s60
  v_mfma_f32_16x16x32_bf16 v[72:75], v[20:23], v[56:59], v[72:75]
  s_nop 0
  v_mfma_f32_16x16x32_bf16 v[76:79], v[20:23], v[60:63], v[76:79]
  v_perm_b32 v48, v134, v130, s59
  v_perm_b32 v49, v142, v138, s59
  v_perm_b32 v50, v150, v146, s59
  v_perm_b32 v51, v158, v154, s59
  v_perm_b32 v52, v134, v130, s60
  v_perm_b32 v53, v142, v138, s60
  v_perm_b32 v54, v150, v146, s60
  v_perm_b32 v55, v158, v154, s60
  v_mfma_f32_16x16x32_bf16 v[80:83], v[20:23], v[48:51], v[80:83]
  s_nop 0
  v_mfma_f32_16x16x32_bf16 v[84:87], v[20:23], v[52:55], v[84:87]
  v_perm_b32 v56, v135, v131, s59
  v_perm_b32 v57, v143, v139, s59
  v_perm_b32 v58, v151, v147, s59
  v_perm_b32 v59, v159, v155, s59
  v_perm_b32 v60, v135, v131, s60
  v_perm_b32 v61, v143, v139, s60
  v_perm_b32 v62, v151, v147, s60
  v_perm_b32 v63, v159, v155, s60
  v_mfma_f32_16x16x32_bf16 v[88:91], v[20:23], v[56:59], v[88:91]
  s_nop 0
  v_mfma_f32_16x16x32_bf16 v[92:95], v[20:23], v[60:63], v[92:95]
  s_waitcnt vmcnt(0)
  v_perm_b32 v48, v164, v160, s59
  v_perm_b32 v49, v172, v168, s59
  v_perm_b32 v50, v180, v176, s59
  v_perm_b32 v51, v188, v184, s59
  v_perm_b32 v52, v164, v160, s60
  v_perm_b32 v53, v172, v168, s60
  v_perm_b32 v54, v180, v176, s60
  v_perm_b32 v55, v188, v184, s60
  v_mfma_f32_16x16x32_bf16 v[64:67], v[24:27], v[48:51], v[64:67]
  s_nop 0
  v_mfma_f32_16x16x32_bf16 v[68:71], v[24:27], v[52:55], v[68:71]
  v_perm_b32 v56, v165, v161, s59
  v_perm_b32 v57, v173, v169, s59
  v_perm_b32 v58, v181, v177, s59
  v_perm_b32 v59, v189, v185, s59
  v_perm_b32 v60, v165, v161, s60
  v_perm_b32 v61, v173, v169, s60
  v_perm_b32 v62, v181, v177, s60
  v_perm_b32 v63, v189, v185, s60
  v_mfma_f32_16x16x32_bf16 v[72:75], v[24:27], v[56:59], v[72:75]
  s_nop 0
  v_mfma_f32_16x16x32_bf16 v[76:79], v[24:27], v[60:63], v[76:79]
  v_perm_b32 v48, v166, v162, s59
  v_perm_b32 v49, v174, v170, s59
  v_perm_b32 v50, v182, v178, s59
  v_perm_b32 v51, v190, v186, s59
  v_perm_b32 v52, v166, v162, s60
  v_perm_b32 v53, v174, v170, s60
  v_perm_b32 v54, v182, v178, s60
  v_perm_b32 v55, v190, v186, s60
  v_mfma_f32_16x16x32_bf16 v[80:83], v[24:27], v[48:51], v[80:83]
  s_nop 0
  v_mfma_f32_16x16x32_bf16 v[84:87], v[24:27], v[52:55], v[84:87]
  v_perm_b32 v56, v167, v163, s59
  v_perm_b32 v57, v175, v171, s59
  v_perm_b32 v58, v183, v179, s59
  v_perm_b32 v59, v191, v187, s59
  v_perm_b32 v60, v167, v163, s60
  v_perm_b32 v61, v175, v171, s60
  v_perm_b32 v62, v183, v179, s60
  v_perm_b32 v63, v191, v187, s60
  v_mfma_f32_16x16x32_bf16 v[88:91], v[24:27], v[56:59], v[88:91]
  s_nop 0
  v_mfma_f32_16x16x32_bf16 v[92:95], v[24:27], v[60:63], v[92:95]
  v_and_b32 v32, 8, v2
  v_cmp_ne_u32 vcc, 0, v32
  s_nop 1
  v_cndmask_b32 v16, v64, v66, vcc
  v_cndmask_b32 v17, v68, v70, vcc
  v_cndmask_b32 v18, v72, v74, vcc
  v_cndmask_b32 v19, v76, v78, vcc
  v_cndmask_b32 v20, v80, v82, vcc
  v_cndmask_b32 v21, v84, v86, vcc
  v_cndmask_b32 v22, v88, v90, vcc
  v_cndmask_b32 v23, v92, v94, vcc
  v_cndmask_b32 v24, v65, v67, vcc
  v_cndmask_b32 v25, v69, v71, vcc
  v_cndmask_b32 v26, v73, v75, vcc
  v_cndmask_b32 v27, v77, v79, vcc
  v_cndmask_b32 v28, v81, v83, vcc
  v_cndmask_b32 v29, v85, v87, vcc
  v_cndmask_b32 v30, v89, v91, vcc
  v_cndmask_b32 v31, v93, v95, vcc
  v_add_f32_dpp v16, v16, v16 row_ror:8 row_mask:0xf bank_mask:0xf
  v_add_f32_dpp v17, v17, v17 row_ror:8 row_mask:0xf bank_mask:0xf
  v_add_f32_dpp v18, v18, v18 row_ror:8 row_mask:0xf bank_mask:0xf
  v_add_f32_dpp v19, v19, v19 row_ror:8 row_mask:0xf bank_mask:0xf
  v_add_f32_dpp v20, v20, v20 row_ror:8 row_mask:0xf bank_mask:0xf
  v_add_f32_dpp v21, v21, v21 row_ror:8 row_mask:0xf bank_mask:0xf
  v_add_f32_dpp v22, v22, v22 row_ror:8 row_mask:0xf bank_mask:0xf
  v_add_f32_dpp v23, v23, v23 row_ror:8 row_mask:0xf bank_mask:0xf
  v_add_f32_dpp v24, v24, v24 row_ror:8 row_mask:0xf bank_mask:0xf
  v_add_f32_dpp v25, v25, v25 row_ror:8 row_mask:0xf bank_mask:0xf
  v_add_f32_dpp v26, v26, v26 row_ror:8 row_mask:0xf bank_mask:0xf
  v_add_f32_dpp v27, v27, v27 row_ror:8 row_mask:0xf bank_mask:0xf
  v_add_f32_dpp v28, v28, v28 row_ror:8 row_mask:0xf bank_mask:0xf
  v_add_f32_dpp v29, v29, v29 row_ror:8 row_mask:0xf bank_mask:0xf
  v_add_f32_dpp v30, v30, v30 row_ror:8 row_mask:0xf bank_mask:0xf
  v_add_f32_dpp v31, v31, v31 row_ror:8 row_mask:0xf bank_mask:0xf
  v_min_u32 v16, -2, v16
  v_min_u32 v17, -2, v17
  v_min_u32 v18, -2, v18
  v_min_u32 v19, -2, v19
  v_min_u32 v20, -2, v20
  v_min_u32 v21, -2, v21
  v_min_u32 v22, -2, v22
  v_min_u32 v23, -2, v23
  v_min_u32 v24, -2, v24
  v_min_u32 v25, -2, v25
  v_min_u32 v26, -2, v26
  v_min_u32 v27, -2, v27
  v_min_u32 v28, -2, v28
  v_min_u32 v29, -2, v29
  v_min_u32 v30, -2, v30
  v_min_u32 v31, -2, v31
  s_mul_i32 s8, s15, 36864
  s_lshl_b32 s9, s70, 8
  s_add_u32 s8, s8, s9
  s_add_u32 s8, s8, 425984
  s_add_u32 s9, s8, 18432
  v_lshlrev_b32 v32, 5, v2
  s_mov_b64 exec, 0xff
  buffer_store_dwordx4 v[16:19], v32, s[52:55], s8 offen sc0 sc1
  buffer_store_dwordx4 v[20:23], v32, s[52:55], s8 offen offset:16 sc0 sc1
  buffer_store_dwordx4 v[24:27], v32, s[52:55], s9 offen sc0 sc1
  buffer_store_dwordx4 v[28:31], v32, s[52:55], s9 offen offset:16 sc0 sc1
  s_mov_b64 exec, -1
  s_nop 0
  s_branch L_aux2
L_att_main:
  s_barrier
  v_and_b32 v6, 1, v2
  v_lshlrev_b32 v6, 8, v6
  v_lshl_add_u32 v6, v3, 4, v6
  ds_read_b128 v[16:19], v6 offset:0
  ds_read_b128 v[20:23], v6 offset:64
  ds_read_b128 v[24:27], v6 offset:128
  ds_read_b128 v[28:31], v6 offset:192
  v_mov_b32 v64, 0
  v_mov_b32 v65, 0
  v_mov_b32 v66, 0
  v_mov_b32 v67, 0
  v_mov_b32 v68, 0
  v_mov_b32 v69, 0
  v_mov_b32 v70, 0
  v_mov_b32 v71, 0
  v_mov_b32 v72, 0
  v_mov_b32 v73, 0
  v_mov_b32 v74, 0
  v_mov_b32 v75, 0
  v_mov_b32 v76, 0
  v_mov_b32 v77, 0
  v_mov_b32 v78, 0
  v_mov_b32 v79, 0
  v_mov_b32 v80, 0
  v_mov_b32 v81, 0
  v_mov_b32 v82, 0
  v_mov_b32 v83, 0
  v_mov_b32 v84, 0
  v_mov_b32 v85, 0
  v_mov_b32 v86, 0
  v_mov_b32 v87, 0
  v_mov_b32 v88, 0
  v_mov_b32 v89, 0
  v_mov_b32 v90, 0
  v_mov_b32 v91, 0
  v_mov_b32 v92, 0
  v_mov_b32 v93, 0
  v_mov_b32 v94, 0
  v_mov_b32 v95, 0
  v_mov_b32 v8, 0xff800000
  v_mov_b32 v9, 0
  v_mov_b32 v10, 0
  s_waitcnt lgkmcnt(0)
  s_mov_b32 s61, 13
  s_mov_b32 s64, 1
  s_mov_b32 s65, 1
L_att_loop:
  s_waitcnt vmcnt(24)
  v_mfma_f32_16x16x32_bf16 v[32:35], v[96:99], v[16:19], 0
  v_mfma_f32_16x16x32_bf16 v[36:39], v[112:115], v[16:19], 0
  v_mfma_f32_16x16x32_bf16 v[32:35], v[100:103], v[20:23], v[32:35]
  v_mfma_f32_16x16x32_bf16 v[36:39], v[116:119], v[20:23], v[36:39]
  v_mfma_f32_16x16x32_bf16 v[32:35], v[104:107], v[24:27], v[32:35]
  v_mfma_f32_16x16x32_bf16 v[36:39], v[120:123], v[24:27], v[36:39]
  v_mfma_f32_16x16x32_bf16 v[32:35], v[108:111], v[28:31], v[32:35]
  v_mfma_f32_16x16x32_bf16 v[36:39], v[124:127], v[28:31], v[36:39]
  buffer_load_dwordx4 v[96:99], v4, s[44:47], s56 offen offset:0 nt
  buffer_load_dwordx4 v[100:103], v4, s[44:47], s56 offen offset:64 nt
  buffer_load_dwordx4 v[104:107], v4, s[44:47], s56 offen offset:128 nt
  buffer_load_dwordx4 v[108:111], v4, s[44:47], s56 offen offset:192 nt
  buffer_load_dwordx4 v[112:115], v4, s[44:47], s57 offen offset:0 nt
  buffer_load_dwordx4 v[116:119], v4, s[44:47], s57 offen offset:64 nt
  buffer_load_dwordx4 v[120:123], v4, s[44:47], s57 offen offset:128 nt
  buffer_load_dwordx4 v[124:127], v4, s[44:47], s57 offen offset:192 nt
  v_cvt_pk_bf16_f32 v40, v32, v33
  v_cvt_pk_bf16_f32 v41, v34, v35
  v_cvt_pk_bf16_f32 v42, v36, v37
  v_cvt_pk_bf16_f32 v43, v38, v39
  v_lshlrev_b32 v32, 16, v40
  v_and_b32 v33, 0xffff0000, v40
  v_lshlrev_b32 v34, 16, v41
  v_and_b32 v35, 0xffff0000, v41
  v_lshlrev_b32 v36, 16, v42
  v_and_b32 v37, 0xffff0000, v42
  v_lshlrev_b32 v38, 16, v43
  v_and_b32 v39, 0xffff0000, v43
  v_mul_f32 v32, s69, v32
  v_mul_f32 v33, s69, v33
  v_mul_f32 v34, s69, v34
  v_mul_f32 v35, s69, v35
  v_mul_f32 v36, s69, v36
  v_mul_f32 v37, s69, v37
  v_mul_f32 v38, s69, v38
  v_mul_f32 v39, s69, v39
  v_cvt_pk_bf16_f32 v40, v32, v33
  v_cvt_pk_bf16_f32 v41, v34, v35
  v_cvt_pk_bf16_f32 v42, v36, v37
  v_cvt_pk_bf16_f32 v43, v38, v39
  v_lshlrev_b32 v32, 16, v40
  v_and_b32 v33, 0xffff0000, v40
  v_lshlrev_b32 v34, 16, v41
  v_and_b32 v35, 0xffff0000, v41
  v_lshlrev_b32 v36, 16, v42
  v_and_b32 v37, 0xffff0000, v42
  v_lshlrev_b32 v38, 16, v43
  v_and_b32 v39, 0xffff0000, v43
  v_max3_f32 v11, v32, v33, v34
  v_max3_f32 v11, v11, v35, v36
  v_max3_f32 v11, v11, v37, v38
  v_max3_f32 v11, v11, v39, v8
  v_mov_b32 v12, v11
  s_nop 1
  v_permlane16_swap_b32 v11, v12
  v_max_f32 v11, v11, v12
  v_mov_b32 v12, v11
  s_nop 1
  v_permlane32_swap_b32 v11, v12
  v_max_f32 v11, v11, v12
  v_cmp_gt_f32 vcc, v11, v8
  s_nop 4
  s_cbranch_vccz L_nors1
  v_sub_f32 v12, v8, v11
  v_mul_f32 v12, s58, v12
  v_exp_f32 v12, v12
  v_mov_b32 v8, v11
  v_mul_f32 v10, s58, v11
  v_sub_f32 v10, 0, v10
  v_mul_f32 v9, v9, v12
  v_mul_f32 v64, v64, v12
  v_mul_f32 v65, v65, v12
  v_mul_f32 v66, v66, v12
  v_mul_f32 v67, v67, v12
  v_mul_f32 v68, v68, v12
  v_mul_f32 v69, v69, v12
  v_mul_f32 v70, v70, v12
  v_mul_f32 v71, v71, v12
  v_mul_f32 v72, v72, v12
  v_mul_f32 v73, v73, v12
  v_mul_f32 v74, v74, v12
  v_mul_f32 v75, v75, v12
  v_mul_f32 v76, v76, v12
  v_mul_f32 v77, v77, v12
  v_mul_f32 v78, v78, v12
  v_mul_f32 v79, v79, v12
  v_mul_f32 v80, v80, v12
  v_mul_f32 v81, v81, v12
  v_mul_f32 v82, v82, v12
  v_mul_f32 v83, v83, v12
  v_mul_f32 v84, v84, v12
  v_mul_f32 v85, v85, v12
  v_mul_f32 v86, v86, v12
  v_mul_f32 v87, v87, v12
  v_mul_f32 v88, v88, v12
  v_mul_f32 v89, v89, v12
  v_mul_f32 v90, v90, v12
  v_mul_f32 v91, v91, v12
  v_mul_f32 v92, v92, v12
  v_mul_f32 v93, v93, v12
  v_mul_f32 v94, v94, v12
  v_mul_f32 v95, v95, v12
  s_nop 1
L_nors1:
  v_fma_f32 v32, v32, s58, v10
  v_fma_f32 v33, v33, s58, v10
  v_fma_f32 v34, v34, s58, v10
  v_fma_f32 v35, v35, s58, v10
  v_fma_f32 v36, v36, s58, v10
  v_fma_f32 v37, v37, s58, v10
  v_fma_f32 v38, v38, s58, v10
  v_fma_f32 v39, v39, s58, v10
  v_exp_f32 v32, v32
  v_exp_f32 v33, v33
  v_exp_f32 v34, v34
  v_exp_f32 v35, v35
  v_exp_f32 v36, v36
  v_exp_f32 v37, v37
  v_exp_f32 v38, v38
  v_exp_f32 v39, v39
  v_cvt_pk_bf16_f32 v40, v32, v33
  v_cvt_pk_bf16_f32 v41, v34, v35
  v_cvt_pk_bf16_f32 v42, v36, v37
  v_cvt_pk_bf16_f32 v43, v38, v39
  v_add_f32 v12, v32, v33
  v_add_f32 v13, v34, v35
  v_add_f32 v14, v36, v37
  v_add_f32 v15, v38, v39
  v_add_f32 v12, v12, v13
  v_add_f32 v14, v14, v15
  v_add_f32 v9, v9, v12
  v_add_f32 v9, v9, v14
  s_waitcnt vmcnt(24)
  v_perm_b32 v48, v164, v160, s59
  v_perm_b32 v49, v172, v168, s59
  v_perm_b32 v50, v180, v176, s59
  v_perm_b32 v51, v188, v184, s59
  v_perm_b32 v52, v164, v160, s60
  v_perm_b32 v53, v172, v168, s60
  v_perm_b32 v54, v180, v176, s60
  v_perm_b32 v55, v188, v184, s60
  v_mfma_f32_16x16x32_bf16 v[64:67], v[48:51], v[40:43], v[64:67]
  s_nop 0
  v_mfma_f32_16x16x32_bf16 v[68:71], v[52:55], v[40:43], v[68:71]
  v_perm_b32 v56, v165, v161, s59
  v_perm_b32 v57, v173, v169, s59
  v_perm_b32 v58, v181, v177, s59
  v_perm_b32 v59, v189, v185, s59
  v_perm_b32 v60, v165, v161, s60
  v_perm_b32 v61, v173, v169, s60
  v_perm_b32 v62, v181, v177, s60
  v_perm_b32 v63, v189, v185, s60
  v_mfma_f32_16x16x32_bf16 v[72:75], v[56:59], v[40:43], v[72:75]
  s_nop 0
  v_mfma_f32_16x16x32_bf16 v[76:79], v[60:63], v[40:43], v[76:79]
  v_perm_b32 v48, v166, v162, s59
  v_perm_b32 v49, v174, v170, s59
  v_perm_b32 v50, v182, v178, s59
  v_perm_b32 v51, v190, v186, s59
  v_perm_b32 v52, v166, v162, s60
  v_perm_b32 v53, v174, v170, s60
  v_perm_b32 v54, v182, v178, s60
  v_perm_b32 v55, v190, v186, s60
  v_mfma_f32_16x16x32_bf16 v[80:83], v[48:51], v[40:43], v[80:83]
  s_nop 0
  v_mfma_f32_16x16x32_bf16 v[84:87], v[52:55], v[40:43], v[84:87]
  v_perm_b32 v56, v167, v163, s59
  v_perm_b32 v57, v175, v171, s59
  v_perm_b32 v58, v183, v179, s59
  v_perm_b32 v59, v191, v187, s59
  v_perm_b32 v60, v167, v163, s60
  v_perm_b32 v61, v175, v171, s60
  v_perm_b32 v62, v183, v179, s60
  v_perm_b32 v63, v191, v187, s60
  v_mfma_f32_16x16x32_bf16 v[88:91], v[56:59], v[40:43], v[88:91]
  s_nop 0
  v_mfma_f32_16x16x32_bf16 v[92:95], v[60:63], v[40:43], v[92:95]
  buffer_load_dwordx4 v[160:163], v5, s[48:51], s56 offen offset:0 nt
  buffer_load_dwordx4 v[164:167], v5, s[48:51], s56 offen offset:256 nt
  buffer_load_dwordx4 v[168:171], v5, s[48:51], s56 offen offset:512 nt
  buffer_load_dwordx4 v[172:175], v5, s[48:51], s56 offen offset:768 nt
  buffer_load_dwordx4 v[176:179], v5, s[48:51], s57 offen offset:0 nt
  buffer_load_dwordx4 v[180:183], v5, s[48:51], s57 offen offset:256 nt
  buffer_load_dwordx4 v[184:187], v5, s[48:51], s57 offen offset:512 nt
  buffer_load_dwordx4 v[188:191], v5, s[48:51], s57 offen offset:768 nt
  s_add_u32 s63, s63, 0x8000
  s_and_b32 s63, s63, 0xf8000
  s_add_u32 s56, s66, s63
  s_add_u32 s57, s56, 4096
  s_waitcnt vmcnt(24)
  v_mfma_f32_16x16x32_bf16 v[32:35], v[128:131], v[16:19], 0
  v_mfma_f32_16x16x32_bf16 v[36:39], v[144:147], v[16:19], 0
  v_mfma_f32_16x16x32_bf16 v[32:35], v[132:135], v[20:23], v[32:35]
  v_mfma_f32_16x16x32_bf16 v[36:39], v[148:151], v[20:23], v[36:39]
  v_mfma_f32_16x16x32_bf16 v[32:35], v[136:139], v[24:27], v[32:35]
  v_mfma_f32_16x16x32_bf16 v[36:39], v[152:155], v[24:27], v[36:39]
  v_mfma_f32_16x16x32_bf16 v[32:35], v[140:143], v[28:31], v[32:35]
  v_mfma_f32_16x16x32_bf16 v[36:39], v[156:159], v[28:31], v[36:39]
  buffer_load_dwordx4 v[128:131], v4, s[44:47], s56 offen offset:0 nt
  buffer_load_dwordx4 v[132:135], v4, s[44:47], s56 offen offset:64 nt
  buffer_load_dwordx4 v[136:139], v4, s[44:47], s56 offen offset:128 nt
  buffer_load_dwordx4 v[140:143], v4, s[44:47], s56 offen offset:192 nt
  buffer_load_dwordx4 v[144:147], v4, s[44:47], s57 offen offset:0 nt
  buffer_load_dwordx4 v[148:151], v4, s[44:47], s57 offen offset:64 nt
  buffer_load_dwordx4 v[152:155], v4, s[44:47], s57 offen offset:128 nt
  buffer_load_dwordx4 v[156:159], v4, s[44:47], s57 offen offset:192 nt
  v_cvt_pk_bf16_f32 v40, v32, v33
  v_cvt_pk_bf16_f32 v41, v34, v35
  v_cvt_pk_bf16_f32 v42, v36, v37
  v_cvt_pk_bf16_f32 v43, v38, v39
  v_lshlrev_b32 v32, 16, v40
  v_and_b32 v33, 0xffff0000, v40
  v_lshlrev_b32 v34, 16, v41
  v_and_b32 v35, 0xffff0000, v41
  v_lshlrev_b32 v36, 16, v42
  v_and_b32 v37, 0xffff0000, v42
  v_lshlrev_b32 v38, 16, v43
  v_and_b32 v39, 0xffff0000, v43
  v_mul_f32 v32, s69, v32
  v_mul_f32 v33, s69, v33
  v_mul_f32 v34, s69, v34
  v_mul_f32 v35, s69, v35
  v_mul_f32 v36, s69, v36
  v_mul_f32 v37, s69, v37
  v_mul_f32 v38, s69, v38
  v_mul_f32 v39, s69, v39
  v_cvt_pk_bf16_f32 v40, v32, v33
  v_cvt_pk_bf16_f32 v41, v34, v35
  v_cvt_pk_bf16_f32 v42, v36, v37
  v_cvt_pk_bf16_f32 v43, v38, v39
  v_lshlrev_b32 v32, 16, v40
  v_and_b32 v33, 0xffff0000, v40
  v_lshlrev_b32 v34, 16, v41
  v_and_b32 v35, 0xffff0000, v41
  v_lshlrev_b32 v36, 16, v42
  v_and_b32 v37, 0xffff0000, v42
  v_lshlrev_b32 v38, 16, v43
  v_and_b32 v39, 0xffff0000, v43
  v_max3_f32 v11, v32, v33, v34
  v_max3_f32 v11, v11, v35, v36
  v_max3_f32 v11, v11, v37, v38
  v_max3_f32 v11, v11, v39, v8
  v_mov_b32 v12, v11
  s_nop 1
  v_permlane16_swap_b32 v11, v12
  v_max_f32 v11, v11, v12
  v_mov_b32 v12, v11
  s_nop 1
  v_permlane32_swap_b32 v11, v12
  v_max_f32 v11, v11, v12
  v_cmp_gt_f32 vcc, v11, v8
  s_nop 4
  s_cbranch_vccz L_nors2
  v_sub_f32 v12, v8, v11
  v_mul_f32 v12, s58, v12
  v_exp_f32 v12, v12
  v_mov_b32 v8, v11
  v_mul_f32 v10, s58, v11
  v_sub_f32 v10, 0, v10
  v_mul_f32 v9, v9, v12
  v_mul_f32 v64, v64, v12
  v_mul_f32 v65, v65, v12
  v_mul_f32 v66, v66, v12
  v_mul_f32 v67, v67, v12
  v_mul_f32 v68, v68, v12
  v_mul_f32 v69, v69, v12
  v_mul_f32 v70, v70, v12
  v_mul_f32 v71, v71, v12
  v_mul_f32 v72, v72, v12
  v_mul_f32 v73, v73, v12
  v_mul_f32 v74, v74, v12
  v_mul_f32 v75, v75, v12
  v_mul_f32 v76, v76, v12
  v_mul_f32 v77, v77, v12
  v_mul_f32 v78, v78, v12
  v_mul_f32 v79, v79, v12
  v_mul_f32 v80, v80, v12
  v_mul_f32 v81, v81, v12
  v_mul_f32 v82, v82, v12
  v_mul_f32 v83, v83, v12
  v_mul_f32 v84, v84, v12
  v_mul_f32 v85, v85, v12
  v_mul_f32 v86, v86, v12
  v_mul_f32 v87, v87, v12
  v_mul_f32 v88, v88, v12
  v_mul_f32 v89, v89, v12
  v_mul_f32 v90, v90, v12
  v_mul_f32 v91, v91, v12
  v_mul_f32 v92, v92, v12
  v_mul_f32 v93, v93, v12
  v_mul_f32 v94, v94, v12
  v_mul_f32 v95, v95, v12
  s_nop 1
L_nors2:
  v_fma_f32 v32, v32, s58, v10
  v_fma_f32 v33, v33, s58, v10
  v_fma_f32 v34, v34, s58, v10
  v_fma_f32 v35, v35, s58, v10
  v_fma_f32 v36, v36, s58, v10
  v_fma_f32 v37, v37, s58, v10
  v_fma_f32 v38, v38, s58, v10
  v_fma_f32 v39, v39, s58, v10
  v_exp_f32 v32, v32
  v_exp_f32 v33, v33
  v_exp_f32 v34, v34
  v_exp_f32 v35, v35
  v_exp_f32 v36, v36
  v_exp_f32 v37, v37
  v_exp_f32 v38, v38
  v_exp_f32 v39, v39
  v_cvt_pk_bf16_f32 v40, v32, v33
  v_cvt_pk_bf16_f32 v41, v34, v35
  v_cvt_pk_bf16_f32 v42, v36, v37
  v_cvt_pk_bf16_f32 v43, v38, v39
  v_add_f32 v12, v32, v33
  v_add_f32 v13, v34, v35
  v_add_f32 v14, v36, v37
  v_add_f32 v15, v38, v39
  v_add_f32 v12, v12, v13
  v_add_f32 v14, v14, v15
  v_add_f32 v9, v9, v12
  v_add_f32 v9, v9, v14
  s_waitcnt vmcnt(24)
  v_perm_b32 v48, v196, v192, s59
  v_perm_b32 v49, v204, v200, s59
  v_perm_b32 v50, v212, v208, s59
  v_perm_b32 v51, v220, v216, s59
  v_perm_b32 v52, v196, v192, s60
  v_perm_b32 v53, v204, v200, s60
  v_perm_b32 v54, v212, v208, s60
  v_perm_b32 v55, v220, v216, s60
  v_mfma_f32_16x16x32_bf16 v[64:67], v[48:51], v[40:43], v[64:67]
  s_nop 0
  v_mfma_f32_16x16x32_bf16 v[68:71], v[52:55], v[40:43], v[68:71]
  v_perm_b32 v56, v197, v193, s59
  v_perm_b32 v57, v205, v201, s59
  v_perm_b32 v58, v213, v209, s59
  v_perm_b32 v59, v221, v217, s59
  v_perm_b32 v60, v197, v193, s60
  v_perm_b32 v61, v205, v201, s60
  v_perm_b32 v62, v213, v209, s60
  v_perm_b32 v63, v221, v217, s60
  v_mfma_f32_16x16x32_bf16 v[72:75], v[56:59], v[40:43], v[72:75]
  s_nop 0
  v_mfma_f32_16x16x32_bf16 v[76:79], v[60:63], v[40:43], v[76:79]
  v_perm_b32 v48, v198, v194, s59
  v_perm_b32 v49, v206, v202, s59
  v_perm_b32 v50, v214, v210, s59
  v_perm_b32 v51, v222, v218, s59
  v_perm_b32 v52, v198, v194, s60
  v_perm_b32 v53, v206, v202, s60
  v_perm_b32 v54, v214, v210, s60
  v_perm_b32 v55, v222, v218, s60
  v_mfma_f32_16x16x32_bf16 v[80:83], v[48:51], v[40:43], v[80:83]
  s_nop 0
  v_mfma_f32_16x16x32_bf16 v[84:87], v[52:55], v[40:43], v[84:87]
  v_perm_b32 v56, v199, v195, s59
  v_perm_b32 v57, v207, v203, s59
  v_perm_b32 v58, v215, v211, s59
  v_perm_b32 v59, v223, v219, s59
  v_perm_b32 v60, v199, v195, s60
  v_perm_b32 v61, v207, v203, s60
  v_perm_b32 v62, v215, v211, s60
  v_perm_b32 v63, v223, v219, s60
  v_mfma_f32_16x16x32_bf16 v[88:91], v[56:59], v[40:43], v[88:91]
  s_nop 0
  v_mfma_f32_16x16x32_bf16 v[92:95], v[60:63], v[40:43], v[92:95]
  buffer_load_dwordx4 v[192:195], v5, s[48:51], s56 offen offset:0 nt
  buffer_load_dwordx4 v[196:199], v5, s[48:51], s56 offen offset:256 nt
  buffer_load_dwordx4 v[200:203], v5, s[48:51], s56 offen offset:512 nt
  buffer_load_dwordx4 v[204:207], v5, s[48:51], s56 offen offset:768 nt
  buffer_load_dwordx4 v[208:211], v5, s[48:51], s57 offen offset:0 nt
  buffer_load_dwordx4 v[212:215], v5, s[48:51], s57 offen offset:256 nt
  buffer_load_dwordx4 v[216:219], v5, s[48:51], s57 offen offset:512 nt
  buffer_load_dwordx4 v[220:223], v5, s[48:51], s57 offen offset:768 nt
  s_add_u32 s63, s63, 0x8000
  s_and_b32 s63, s63, 0xf8000
  s_add_u32 s56, s66, s63
  s_add_u32 s57, s56, 4096
  s_sub_u32 s61, s61, 1
  s_cmp_lg_u32 s61, 0
  s_cbranch_scc1 L_att_loop
  s_waitcnt vmcnt(24)
  v_mfma_f32_16x16x32_bf16 v[32:35], v[96:99], v[16:19], 0
  v_mfma_f32_16x16x32_bf16 v[36:39], v[112:115], v[16:19], 0
  v_mfma_f32_16x16x32_bf16 v[32:35], v[100:103], v[20:23], v[32:35]
  v_mfma_f32_16x16x32_bf16 v[36:39], v[116:119], v[20:23], v[36:39]
  v_mfma_f32_16x16x32_bf16 v[32:35], v[104:107], v[24:27], v[32:35]
  v_mfma_f32_16x16x32_bf16 v[36:39], v[120:123], v[24:27], v[36:39]
  v_mfma_f32_16x16x32_bf16 v[32:35], v[108:111], v[28:31], v[32:35]
  v_mfma_f32_16x16x32_bf16 v[36:39], v[124:127], v[28:31], v[36:39]
  buffer_load_dwordx4 v[96:99], v4, s[44:47], s56 offen offset:0 nt
  buffer_load_dwordx4 v[100:103], v4, s[44:47], s56 offen offset:64 nt
  buffer_load_dwordx4 v[104:107], v4, s[44:47], s56 offen offset:128 nt
  buffer_load_dwordx4 v[108:111], v4, s[44:47], s56 offen offset:192 nt
  buffer_load_dwordx4 v[112:115], v4, s[44:47], s57 offen offset:0 nt
  buffer_load_dwordx4 v[116:119], v4, s[44:47], s57 offen offset:64 nt
  buffer_load_dwordx4 v[120:123], v4, s[44:47], s57 offen offset:128 nt
  buffer_load_dwordx4 v[124:127], v4, s[44:47], s57 offen offset:192 nt
  v_cvt_pk_bf16_f32 v40, v32, v33
  v_cvt_pk_bf16_f32 v41, v34, v35
  v_cvt_pk_bf16_f32 v42, v36, v37
  v_cvt_pk_bf16_f32 v43, v38, v39
  v_lshlrev_b32 v32, 16, v40
  v_and_b32 v33, 0xffff0000, v40
  v_lshlrev_b32 v34, 16, v41
  v_and_b32 v35, 0xffff0000, v41
  v_lshlrev_b32 v36, 16, v42
  v_and_b32 v37, 0xffff0000, v42
  v_lshlrev_b32 v38, 16, v43
  v_and_b32 v39, 0xffff0000, v43
  v_mul_f32 v32, s69, v32
  v_mul_f32 v33, s69, v33
  v_mul_f32 v34, s69, v34
  v_mul_f32 v35, s69, v35
  v_mul_f32 v36, s69, v36
  v_mul_f32 v37, s69, v37
  v_mul_f32 v38, s69, v38
  v_mul_f32 v39, s69, v39
  v_cvt_pk_bf16_f32 v40, v32, v33
  v_cvt_pk_bf16_f32 v41, v34, v35
  v_cvt_pk_bf16_f32 v42, v36, v37
  v_cvt_pk_bf16_f32 v43, v38, v39
  v_lshlrev_b32 v32, 16, v40
  v_and_b32 v33, 0xffff0000, v40
  v_lshlrev_b32 v34, 16, v41
  v_and_b32 v35, 0xffff0000, v41
  v_lshlrev_b32 v36, 16, v42
  v_and_b32 v37, 0xffff0000, v42
  v_lshlrev_b32 v38, 16, v43
  v_and_b32 v39, 0xffff0000, v43
  v_max3_f32 v11, v32, v33, v34
  v_max3_f32 v11, v11, v35, v36
  v_max3_f32 v11, v11, v37, v38
  v_max3_f32 v11, v11, v39, v8
  v_mov_b32 v12, v11
  s_nop 1
  v_permlane16_swap_b32 v11, v12
  v_max_f32 v11, v11, v12
  v_mov_b32 v12, v11
  s_nop 1
  v_permlane32_swap_b32 v11, v12
  v_max_f32 v11, v11, v12
  v_cmp_gt_f32 vcc, v11, v8
  s_nop 4
  s_cbranch_vccz L_nors3
  v_sub_f32 v12, v8, v11
  v_mul_f32 v12, s58, v12
  v_exp_f32 v12, v12
  v_mov_b32 v8, v11
  v_mul_f32 v10, s58, v11
  v_sub_f32 v10, 0, v10
  v_mul_f32 v9, v9, v12
  v_mul_f32 v64, v64, v12
  v_mul_f32 v65, v65, v12
  v_mul_f32 v66, v66, v12
  v_mul_f32 v67, v67, v12
  v_mul_f32 v68, v68, v12
  v_mul_f32 v69, v69, v12
  v_mul_f32 v70, v70, v12
  v_mul_f32 v71, v71, v12
  v_mul_f32 v72, v72, v12
  v_mul_f32 v73, v73, v12
  v_mul_f32 v74, v74, v12
  v_mul_f32 v75, v75, v12
  v_mul_f32 v76, v76, v12
  v_mul_f32 v77, v77, v12
  v_mul_f32 v78, v78, v12
  v_mul_f32 v79, v79, v12
  v_mul_f32 v80, v80, v12
  v_mul_f32 v81, v81, v12
  v_mul_f32 v82, v82, v12
  v_mul_f32 v83, v83, v12
  v_mul_f32 v84, v84, v12
  v_mul_f32 v85, v85, v12
  v_mul_f32 v86, v86, v12
  v_mul_f32 v87, v87, v12
  v_mul_f32 v88, v88, v12
  v_mul_f32 v89, v89, v12
  v_mul_f32 v90, v90, v12
  v_mul_f32 v91, v91, v12
  v_mul_f32 v92, v92, v12
  v_mul_f32 v93, v93, v12
  v_mul_f32 v94, v94, v12
  v_mul_f32 v95, v95, v12
  s_nop 1
L_nors3:
  v_fma_f32 v32, v32, s58, v10
  v_fma_f32 v33, v33, s58, v10
  v_fma_f32 v34, v34, s58, v10
  v_fma_f32 v35, v35, s58, v10
  v_fma_f32 v36, v36, s58, v10
  v_fma_f32 v37, v37, s58, v10
  v_fma_f32 v38, v38, s58, v10
  v_fma_f32 v39, v39, s58, v10
  v_exp_f32 v32, v32
  v_exp_f32 v33, v33
  v_exp_f32 v34, v34
  v_exp_f32 v35, v35
  v_exp_f32 v36, v36
  v_exp_f32 v37, v37
  v_exp_f32 v38, v38
  v_exp_f32 v39, v39
  v_cvt_pk_bf16_f32 v40, v32, v33
  v_cvt_pk_bf16_f32 v41, v34, v35
  v_cvt_pk_bf16_f32 v42, v36, v37
  v_cvt_pk_bf16_f32 v43, v38, v39
  v_add_f32 v12, v32, v33
  v_add_f32 v13, v34, v35
  v_add_f32 v14, v36, v37
  v_add_f32 v15, v38, v39
  v_add_f32 v12, v12, v13
  v_add_f32 v14, v14, v15
  v_add_f32 v9, v9, v12
  v_add_f32 v9, v9, v14
  s_waitcnt vmcnt(24)
  v_perm_b32 v48, v164, v160, s59
  v_perm_b32 v49, v172, v168, s59
  v_perm_b32 v50, v180, v176, s59
  v_perm_b32 v51, v188, v184, s59
  v_perm_b32 v52, v164, v160, s60
  v_perm_b32 v53, v172, v168, s60
  v_perm_b32 v54, v180, v176, s60
  v_perm_b32 v55, v188, v184, s60
  v_mfma_f32_16x16x32_bf16 v[64:67], v[48:51], v[40:43], v[64:67]
  s_nop 0
  v_mfma_f32_16x16x32_bf16 v[68:71], v[52:55], v[40:43], v[68:71]
  v_perm_b32 v56, v165, v161, s59
  v_perm_b32 v57, v173, v169, s59
  v_perm_b32 v58, v181, v177, s59
  v_perm_b32 v59, v189, v185, s59
  v_perm_b32 v60, v165, v161, s60
  v_perm_b32 v61, v173, v169, s60
  v_perm_b32 v62, v181, v177, s60
  v_perm_b32 v63, v189, v185, s60
  v_mfma_f32_16x16x32_bf16 v[72:75], v[56:59], v[40:43], v[72:75]
  s_nop 0
  v_mfma_f32_16x16x32_bf16 v[76:79], v[60:63], v[40:43], v[76:79]
  v_perm_b32 v48, v166, v162, s59
  v_perm_b32 v49, v174, v170, s59
  v_perm_b32 v50, v182, v178, s59
  v_perm_b32 v51, v190, v186, s59
  v_perm_b32 v52, v166, v162, s60
  v_perm_b32 v53, v174, v170, s60
  v_perm_b32 v54, v182, v178, s60
  v_perm_b32 v55, v190, v186, s60
  v_mfma_f32_16x16x32_bf16 v[80:83], v[48:51], v[40:43], v[80:83]
  s_nop 0
  v_mfma_f32_16x16x32_bf16 v[84:87], v[52:55], v[40:43], v[84:87]
  v_perm_b32 v56, v167, v163, s59
  v_perm_b32 v57, v175, v171, s59
  v_perm_b32 v58, v183, v179, s59
  v_perm_b32 v59, v191, v187, s59
  v_perm_b32 v60, v167, v163, s60
  v_perm_b32 v61, v175, v171, s60
  v_perm_b32 v62, v183, v179, s60
  v_perm_b32 v63, v191, v187, s60
  v_mfma_f32_16x16x32_bf16 v[88:91], v[56:59], v[40:43], v[88:91]
  s_nop 0
  v_mfma_f32_16x16x32_bf16 v[92:95], v[60:63], v[40:43], v[92:95]
  buffer_load_dwordx4 v[160:163], v5, s[48:51], s56 offen offset:0 nt
  buffer_load_dwordx4 v[164:167], v5, s[48:51], s56 offen offset:256 nt
  buffer_load_dwordx4 v[168:171], v5, s[48:51], s56 offen offset:512 nt
  buffer_load_dwordx4 v[172:175], v5, s[48:51], s56 offen offset:768 nt
  buffer_load_dwordx4 v[176:179], v5, s[48:51], s57 offen offset:0 nt
  buffer_load_dwordx4 v[180:183], v5, s[48:51], s57 offen offset:256 nt
  buffer_load_dwordx4 v[184:187], v5, s[48:51], s57 offen offset:512 nt
  buffer_load_dwordx4 v[188:191], v5, s[48:51], s57 offen offset:768 nt
  s_add_u32 s63, s63, 0x8000
  s_and_b32 s63, s63, 0xf8000
  s_add_u32 s56, s66, s63
  s_add_u32 s57, s56, 4096
  s_waitcnt vmcnt(24)
  v_mfma_f32_16x16x32_bf16 v[32:35], v[128:131], v[16:19], 0
  v_mfma_f32_16x16x32_bf16 v[36:39], v[144:147], v[16:19], 0
  v_mfma_f32_16x16x32_bf16 v[32:35], v[132:135], v[20:23], v[32:35]
  v_mfma_f32_16x16x32_bf16 v[36:39], v[148:151], v[20:23], v[36:39]
  v_mfma_f32_16x16x32_bf16 v[32:35], v[136:139], v[24:27], v[32:35]
  v_mfma_f32_16x16x32_bf16 v[36:39], v[152:155], v[24:27], v[36:39]
  v_mfma_f32_16x16x32_bf16 v[32:35], v[140:143], v[28:31], v[32:35]
  v_mfma_f32_16x16x32_bf16 v[36:39], v[156:159], v[28:31], v[36:39]
  s_mov_b64 exec, 1
  v_mov_b32 v225, 1
  buffer_atomic_add v225, v226, s[52:55], s62 offen sc0 sc1
  s_mov_b64 exec, -1
  buffer_load_dwordx4 v[128:131], v4, s[44:47], s56 offen offset:0 nt
  buffer_load_dwordx4 v[132:135], v4, s[44:47], s56 offen offset:64 nt
  buffer_load_dwordx4 v[136:139], v4, s[44:47], s56 offen offset:128 nt
  buffer_load_dwordx4 v[140:143], v4, s[44:47], s56 offen offset:192 nt
  buffer_load_dwordx4 v[144:147], v4, s[44:47], s57 offen offset:0 nt
  buffer_load_dwordx4 v[148:151], v4, s[44:47], s57 offen offset:64 nt
  buffer_load_dwordx4 v[152:155], v4, s[44:47], s57 offen offset:128 nt
  buffer_load_dwordx4 v[156:159], v4, s[44:47], s57 offen offset:192 nt
  v_cvt_pk_bf16_f32 v40, v32, v33
  v_cvt_pk_bf16_f32 v41, v34, v35
  v_cvt_pk_bf16_f32 v42, v36, v37
  v_cvt_pk_bf16_f32 v43, v38, v39
  v_lshlrev_b32 v32, 16, v40
  v_and_b32 v33, 0xffff0000, v40
  v_lshlrev_b32 v34, 16, v41
  v_and_b32 v35, 0xffff0000, v41
  v_lshlrev_b32 v36, 16, v42
  v_and_b32 v37, 0xffff0000, v42
  v_lshlrev_b32 v38, 16, v43
  v_and_b32 v39, 0xffff0000, v43
  v_mul_f32 v32, s69, v32
  v_mul_f32 v33, s69, v33
  v_mul_f32 v34, s69, v34
  v_mul_f32 v35, s69, v35
  v_mul_f32 v36, s69, v36
  v_mul_f32 v37, s69, v37
  v_mul_f32 v38, s69, v38
  v_mul_f32 v39, s69, v39
  v_cvt_pk_bf16_f32 v40, v32, v33
  v_cvt_pk_bf16_f32 v41, v34, v35
  v_cvt_pk_bf16_f32 v42, v36, v37
  v_cvt_pk_bf16_f32 v43, v38, v39
  v_lshlrev_b32 v32, 16, v40
  v_and_b32 v33, 0xffff0000, v40
  v_lshlrev_b32 v34, 16, v41
  v_and_b32 v35, 0xffff0000, v41
  v_lshlrev_b32 v36, 16, v42
  v_and_b32 v37, 0xffff0000, v42
  v_lshlrev_b32 v38, 16, v43
  v_and_b32 v39, 0xffff0000, v43
  v_max3_f32 v11, v32, v33, v34
  v_max3_f32 v11, v11, v35, v36
  v_max3_f32 v11, v11, v37, v38
  v_max3_f32 v11, v11, v39, v8
  v_mov_b32 v12, v11
  s_nop 1
  v_permlane16_swap_b32 v11, v12
  v_max_f32 v11, v11, v12
  v_mov_b32 v12, v11
  s_nop 1
  v_permlane32_swap_b32 v11, v12
  v_max_f32 v11, v11, v12
  v_cmp_gt_f32 vcc, v11, v8
  s_nop 4
  s_cbranch_vccz L_nors4
  v_sub_f32 v12, v8, v11
  v_mul_f32 v12, s58, v12
  v_exp_f32 v12, v12
  v_mov_b32 v8, v11
  v_mul_f32 v10, s58, v11
  v_sub_f32 v10, 0, v10
  v_mul_f32 v9, v9, v12
  v_mul_f32 v64, v64, v12
  v_mul_f32 v65, v65, v12
  v_mul_f32 v66, v66, v12
  v_mul_f32 v67, v67, v12
  v_mul_f32 v68, v68, v12
  v_mul_f32 v69, v69, v12
  v_mul_f32 v70, v70, v12
  v_mul_f32 v71, v71, v12
  v_mul_f32 v72, v72, v12
  v_mul_f32 v73, v73, v12
  v_mul_f32 v74, v74, v12
  v_mul_f32 v75, v75, v12
  v_mul_f32 v76, v76, v12
  v_mul_f32 v77, v77, v12
  v_mul_f32 v78, v78, v12
  v_mul_f32 v79, v79, v12
  v_mul_f32 v80, v80, v12
  v_mul_f32 v81, v81, v12
  v_mul_f32 v82, v82, v12
  v_mul_f32 v83, v83, v12
  v_mul_f32 v84, v84, v12
  v_mul_f32 v85, v85, v12
  v_mul_f32 v86, v86, v12
  v_mul_f32 v87, v87, v12
  v_mul_f32 v88, v88, v12
  v_mul_f32 v89, v89, v12
  v_mul_f32 v90, v90, v12
  v_mul_f32 v91, v91, v12
  v_mul_f32 v92, v92, v12
  v_mul_f32 v93, v93, v12
  v_mul_f32 v94, v94, v12
  v_mul_f32 v95, v95, v12
  s_nop 1
L_nors4:
  v_fma_f32 v32, v32, s58, v10
  v_fma_f32 v33, v33, s58, v10
  v_fma_f32 v34, v34, s58, v10
  v_fma_f32 v35, v35, s58, v10
  v_fma_f32 v36, v36, s58, v10
  v_fma_f32 v37, v37, s58, v10
  v_fma_f32 v38, v38, s58, v10
  v_fma_f32 v39, v39, s58, v10
  v_exp_f32 v32, v32
  v_exp_f32 v33, v33
  v_exp_f32 v34, v34
  v_exp_f32 v35, v35
  v_exp_f32 v36, v36
  v_exp_f32 v37, v37
  v_exp_f32 v38, v38
  v_exp_f32 v39, v39
  v_cvt_pk_bf16_f32 v40, v32, v33
  v_cvt_pk_bf16_f32 v41, v34, v35
  v_cvt_pk_bf16_f32 v42, v36, v37
  v_cvt_pk_bf16_f32 v43, v38, v39
  v_add_f32 v12, v32, v33
  v_add_f32 v13, v34, v35
  v_add_f32 v14, v36, v37
  v_add_f32 v15, v38, v39
  v_add_f32 v12, v12, v13
  v_add_f32 v14, v14, v15
  v_add_f32 v9, v9, v12
  v_add_f32 v9, v9, v14
  s_waitcnt vmcnt(25)
  v_perm_b32 v48, v196, v192, s59
  v_perm_b32 v49, v204, v200, s59
  v_perm_b32 v50, v212, v208, s59
  v_perm_b32 v51, v220, v216, s59
  v_perm_b32 v52, v196, v192, s60
  v_perm_b32 v53, v204, v200, s60
  v_perm_b32 v54, v212, v208, s60
  v_perm_b32 v55, v220, v216, s60
  v_mfma_f32_16x16x32_bf16 v[64:67], v[48:51], v[40:43], v[64:67]
  s_nop 0
  v_mfma_f32_16x16x32_bf16 v[68:71], v[52:55], v[40:43], v[68:71]
  v_perm_b32 v56, v197, v193, s59
  v_perm_b32 v57, v205, v201, s59
  v_perm_b32 v58, v213, v209, s59
  v_perm_b32 v59, v221, v217, s59
  v_perm_b32 v60, v197, v193, s60
  v_perm_b32 v61, v205, v201, s60
  v_perm_b32 v62, v213, v209, s60
  v_perm_b32 v63, v221, v217, s60
  v_mfma_f32_16x16x32_bf16 v[72:75], v[56:59], v[40:43], v[72:75]
  s_nop 0
  v_mfma_f32_16x16x32_bf16 v[76:79], v[60:63], v[40:43], v[76:79]
  v_perm_b32 v48, v198, v194, s59
  v_perm_b32 v49, v206, v202, s59
  v_perm_b32 v50, v214, v210, s59
  v_perm_b32 v51, v222, v218, s59
  v_perm_b32 v52, v198, v194, s60
  v_perm_b32 v53, v206, v202, s60
  v_perm_b32 v54, v214, v210, s60
  v_perm_b32 v55, v222, v218, s60
  v_mfma_f32_16x16x32_bf16 v[80:83], v[48:51], v[40:43], v[80:83]
  s_nop 0
  v_mfma_f32_16x16x32_bf16 v[84:87], v[52:55], v[40:43], v[84:87]
  v_perm_b32 v56, v199, v195, s59
  v_perm_b32 v57, v207, v203, s59
  v_perm_b32 v58, v215, v211, s59
  v_perm_b32 v59, v223, v219, s59
  v_perm_b32 v60, v199, v195, s60
  v_perm_b32 v61, v207, v203, s60
  v_perm_b32 v62, v215, v211, s60
  v_perm_b32 v63, v223, v219, s60
  v_mfma_f32_16x16x32_bf16 v[88:91], v[56:59], v[40:43], v[88:91]
  s_nop 0
  v_mfma_f32_16x16x32_bf16 v[92:95], v[60:63], v[40:43], v[92:95]
  buffer_load_dwordx4 v[192:195], v5, s[48:51], s56 offen offset:0 nt
  buffer_load_dwordx4 v[196:199], v5, s[48:51], s56 offen offset:256 nt
  buffer_load_dwordx4 v[200:203], v5, s[48:51], s56 offen offset:512 nt
  buffer_load_dwordx4 v[204:207], v5, s[48:51], s56 offen offset:768 nt
  buffer_load_dwordx4 v[208:211], v5, s[48:51], s57 offen offset:0 nt
  buffer_load_dwordx4 v[212:215], v5, s[48:51], s57 offen offset:256 nt
  buffer_load_dwordx4 v[216:219], v5, s[48:51], s57 offen offset:512 nt
  buffer_load_dwordx4 v[220:223], v5, s[48:51], s57 offen offset:768 nt
  s_add_u32 s63, s63, 0x8000
  s_and_b32 s63, s63, 0xf8000
  s_add_u32 s56, s66, s63
  s_add_u32 s57, s56, 4096
L_dyn_loop:
  s_waitcnt vmcnt(25)
  v_mfma_f32_16x16x32_bf16 v[32:35], v[96:99], v[16:19], 0
  v_mfma_f32_16x16x32_bf16 v[36:39], v[112:115], v[16:19], 0
  v_mfma_f32_16x16x32_bf16 v[32:35], v[100:103], v[20:23], v[32:35]
  v_mfma_f32_16x16x32_bf16 v[36:39], v[116:119], v[20:23], v[36:39]
  v_mfma_f32_16x16x32_bf16 v[32:35], v[104:107], v[24:27], v[32:35]
  v_mfma_f32_16x16x32_bf16 v[36:39], v[120:123], v[24:27], v[36:39]
  v_mfma_f32_16x16x32_bf16 v[32:35], v[108:111], v[28:31], v[32:35]
  v_mfma_f32_16x16x32_bf16 v[36:39], v[124:127], v[28:31], v[36:39]
  s_waitcnt vmcnt(16)
  v_readfirstlane_b32 s8, v225
  s_nop 0
  s_and_b32 s9, s8, 7
  s_lshl_b32 s9, s9, 20
  s_bfe_u32 s10, s8, 0x20003
  s_lshl_b32 s10, s10, 13
  s_add_u32 s9, s9, s10
  s_lshr_b32 s10, s8, 5
  s_add_u32 s10, s10, 30
  s_lshl_b32 s10, s10, 15
  s_add_u32 s10, s10, s67
  s_and_b32 s10, s10, 0xf8000
  s_add_u32 s56, s9, s10
  s_add_u32 s57, s56, 4096
  s_cmp_lt_u32 s8, 64
  s_cselect_b32 s64, 1, 0
  s_cbranch_scc0 L_drain0
  s_mov_b64 exec, 1
  v_mov_b32 v224, 1
  buffer_atomic_add v224, v226, s[52:55], s62 offen sc0 sc1
  s_mov_b64 exec, -1
  buffer_load_dwordx4 v[96:99], v4, s[44:47], s56 offen offset:0 nt
  buffer_load_dwordx4 v[100:103], v4, s[44:47], s56 offen offset:64 nt
  buffer_load_dwordx4 v[104:107], v4, s[44:47], s56 offen offset:128 nt
  buffer_load_dwordx4 v[108:111], v4, s[44:47], s56 offen offset:192 nt
  buffer_load_dwordx4 v[112:115], v4, s[44:47], s57 offen offset:0 nt
  buffer_load_dwordx4 v[116:119], v4, s[44:47], s57 offen offset:64 nt
  buffer_load_dwordx4 v[120:123], v4, s[44:47], s57 offen offset:128 nt
  buffer_load_dwordx4 v[124:127], v4, s[44:47], s57 offen offset:192 nt
  v_cvt_pk_bf16_f32 v40, v32, v33
  v_cvt_pk_bf16_f32 v41, v34, v35
  v_cvt_pk_bf16_f32 v42, v36, v37
  v_cvt_pk_bf16_f32 v43, v38, v39
  v_lshlrev_b32 v32, 16, v40
  v_and_b32 v33, 0xffff0000, v40
  v_lshlrev_b32 v34, 16, v41
  v_and_b32 v35, 0xffff0000, v41
  v_lshlrev_b32 v36, 16, v42
  v_and_b32 v37, 0xffff0000, v42
  v_lshlrev_b32 v38, 16, v43
  v_and_b32 v39, 0xffff0000, v43
  v_mul_f32 v32, s69, v32
  v_mul_f32 v33, s69, v33
  v_mul_f32 v34, s69, v34
  v_mul_f32 v35, s69, v35
  v_mul_f32 v36, s69, v36
  v_mul_f32 v37, s69, v37
  v_mul_f32 v38, s69, v38
  v_mul_f32 v39, s69, v39
  v_cvt_pk_bf16_f32 v40, v32, v33
  v_cvt_pk_bf16_f32 v41, v34, v35
  v_cvt_pk_bf16_f32 v42, v36, v37
  v_cvt_pk_bf16_f32 v43, v38, v39
  v_lshlrev_b32 v32, 16, v40
  v_and_b32 v33, 0xffff0000, v40
  v_lshlrev_b32 v34, 16, v41
  v_and_b32 v35, 0xffff0000, v41
  v_lshlrev_b32 v36, 16, v42
  v_and_b32 v37, 0xffff0000, v42
  v_lshlrev_b32 v38, 16, v43
  v_and_b32 v39, 0xffff0000, v43
  v_max3_f32 v11, v32, v33, v34
  v_max3_f32 v11, v11, v35, v36
  v_max3_f32 v11, v11, v37, v38
  v_max3_f32 v11, v11, v39, v8
  v_mov_b32 v12, v11
  s_nop 1
  v_permlane16_swap_b32 v11, v12
  v_max_f32 v11, v11, v12
  v_mov_b32 v12, v11
  s_nop 1
  v_permlane32_swap_b32 v11, v12
  v_max_f32 v11, v11, v12
  v_cmp_gt_f32 vcc, v11, v8
  s_nop 4
  s_cbranch_vccz L_nors5
  v_sub_f32 v12, v8, v11
  v_mul_f32 v12, s58, v12
  v_exp_f32 v12, v12
  v_mov_b32 v8, v11
  v_mul_f32 v10, s58, v11
  v_sub_f32 v10, 0, v10
  v_mul_f32 v9, v9, v12
  v_mul_f32 v64, v64, v12
  v_mul_f32 v65, v65, v12
  v_mul_f32 v66, v66, v12
  v_mul_f32 v67, v67, v12
  v_mul_f32 v68, v68, v12
  v_mul_f32 v69, v69, v12
  v_mul_f32 v70, v70, v12
  v_mul_f32 v71, v71, v12
  v_mul_f32 v72, v72, v12
  v_mul_f32 v73, v73, v12
  v_mul_f32 v74, v74, v12
  v_mul_f32 v75, v75, v12
  v_mul_f32 v76, v76, v12
  v_mul_f32 v77, v77, v12
  v_mul_f32 v78, v78, v12
  v_mul_f32 v79, v79, v12
  v_mul_f32 v80, v80, v12
  v_mul_f32 v81, v81, v12
  v_mul_f32 v82, v82, v12
  v_mul_f32 v83, v83, v12
  v_mul_f32 v84, v84, v12
  v_mul_f32 v85, v85, v12
  v_mul_f32 v86, v86, v12
  v_mul_f32 v87, v87, v12
  v_mul_f32 v88, v88, v12
  v_mul_f32 v89, v89, v12
  v_mul_f32 v90, v90, v12
  v_mul_f32 v91, v91, v12
  v_mul_f32 v92, v92, v12
  v_mul_f32 v93, v93, v12
  v_mul_f32 v94, v94, v12
  v_mul_f32 v95, v95, v12
  s_nop 1
L_nors5:
  v_fma_f32 v32, v32, s58, v10
  v_fma_f32 v33, v33, s58, v10
  v_fma_f32 v34, v34, s58, v10
  v_fma_f32 v35, v35, s58, v10
  v_fma_f32 v36, v36, s58, v10
  v_fma_f32 v37, v37, s58, v10
  v_fma_f32 v38, v38, s58, v10
  v_fma_f32 v39, v39, s58, v10
  v_exp_f32 v32, v32
  v_exp_f32 v33, v33
  v_exp_f32 v34, v34
  v_exp_f32 v35, v35
  v_exp_f32 v36, v36
  v_exp_f32 v37, v37
  v_exp_f32 v38, v38
  v_exp_f32 v39, v39
  v_cvt_pk_bf16_f32 v40, v32, v33
  v_cvt_pk_bf16_f32 v41, v34, v35
  v_cvt_pk_bf16_f32 v42, v36, v37
  v_cvt_pk_bf16_f32 v43, v38, v39
  v_add_f32 v12, v32, v33
  v_add_f32 v13, v34, v35
  v_add_f32 v14, v36, v37
  v_add_f32 v15, v38, v39
  v_add_f32 v12, v12, v13
  v_add_f32 v14, v14, v15
  v_add_f32 v9, v9, v12
  v_add_f32 v9, v9, v14
  s_waitcnt vmcnt(26)
  v_perm_b32 v48, v164, v160, s59
  v_perm_b32 v49, v172, v168, s59
  v_perm_b32 v50, v180, v176, s59
  v_perm_b32 v51, v188, v184, s59
  v_perm_b32 v52, v164, v160, s60
  v_perm_b32 v53, v172, v168, s60
  v_perm_b32 v54, v180, v176, s60
  v_perm_b32 v55, v188, v184, s60
  v_mfma_f32_16x16x32_bf16 v[64:67], v[48:51], v[40:43], v[64:67]
  s_nop 0
  v_mfma_f32_16x16x32_bf16 v[68:71], v[52:55], v[40:43], v[68:71]
  v_perm_b32 v56, v165, v161, s59
  v_perm_b32 v57, v173, v169, s59
  v_perm_b32 v58, v181, v177, s59
  v_perm_b32 v59, v189, v185, s59
  v_perm_b32 v60, v165, v161, s60
  v_perm_b32 v61, v173, v169, s60
  v_perm_b32 v62, v181, v177, s60
  v_perm_b32 v63, v189, v185, s60
  v_mfma_f32_16x16x32_bf16 v[72:75], v[56:59], v[40:43], v[72:75]
  s_nop 0
  v_mfma_f32_16x16x32_bf16 v[76:79], v[60:63], v[40:43], v[76:79]
  v_perm_b32 v48, v166, v162, s59
  v_perm_b32 v49, v174, v170, s59
  v_perm_b32 v50, v182, v178, s59
  v_perm_b32 v51, v190, v186, s59
  v_perm_b32 v52, v166, v162, s60
  v_perm_b32 v53, v174, v170, s60
  v_perm_b32 v54, v182, v178, s60
  v_perm_b32 v55, v190, v186, s60
  v_mfma_f32_16x16x32_bf16 v[80:83], v[48:51], v[40:43], v[80:83]
  s_nop 0
  v_mfma_f32_16x16x32_bf16 v[84:87], v[52:55], v[40:43], v[84:87]
  v_perm_b32 v56, v167, v163, s59
  v_perm_b32 v57, v175, v171, s59
  v_perm_b32 v58, v183, v179, s59
  v_perm_b32 v59, v191, v187, s59
  v_perm_b32 v60, v167, v163, s60
  v_perm_b32 v61, v175, v171, s60
  v_perm_b32 v62, v183, v179, s60
  v_perm_b32 v63, v191, v187, s60
  v_mfma_f32_16x16x32_bf16 v[88:91], v[56:59], v[40:43], v[88:91]
  s_nop 0
  v_mfma_f32_16x16x32_bf16 v[92:95], v[60:63], v[40:43], v[92:95]
  buffer_load_dwordx4 v[160:163], v5, s[48:51], s56 offen offset:0 nt
  buffer_load_dwordx4 v[164:167], v5, s[48:51], s56 offen offset:256 nt
  buffer_load_dwordx4 v[168:171], v5, s[48:51], s56 offen offset:512 nt
  buffer_load_dwordx4 v[172:175], v5, s[48:51], s56 offen offset:768 nt
  buffer_load_dwordx4 v[176:179], v5, s[48:51], s57 offen offset:0 nt
  buffer_load_dwordx4 v[180:183], v5, s[48:51], s57 offen offset:256 nt
  buffer_load_dwordx4 v[184:187], v5, s[48:51], s57 offen offset:512 nt
  buffer_load_dwordx4 v[188:191], v5, s[48:51], s57 offen offset:768 nt
  s_waitcnt vmcnt(25)
  v_mfma_f32_16x16x32_bf16 v[32:35], v[128:131], v[16:19], 0
  v_mfma_f32_16x16x32_bf16 v[36:39], v[144:147], v[16:19], 0
  v_mfma_f32_16x16x32_bf16 v[32:35], v[132:135], v[20:23], v[32:35]
  v_mfma_f32_16x16x32_bf16 v[36:39], v[148:151], v[20:23], v[36:39]
  v_mfma_f32_16x16x32_bf16 v[32:35], v[136:139], v[24:27], v[32:35]
  v_mfma_f32_16x16x32_bf16 v[36:39], v[152:155], v[24:27], v[36:39]
  v_mfma_f32_16x16x32_bf16 v[32:35], v[140:143], v[28:31], v[32:35]
  v_mfma_f32_16x16x32_bf16 v[36:39], v[156:159], v[28:31], v[36:39]
  s_waitcnt vmcnt(16)
  v_readfirstlane_b32 s8, v224
  s_nop 0
  s_and_b32 s9, s8, 7
  s_lshl_b32 s9, s9, 20
  s_bfe_u32 s10, s8, 0x20003
  s_lshl_b32 s10, s10, 13
  s_add_u32 s9, s9, s10
  s_lshr_b32 s10, s8, 5
  s_add_u32 s10, s10, 30
  s_lshl_b32 s10, s10, 15
  s_add_u32 s10, s10, s67
  s_and_b32 s10, s10, 0xf8000
  s_add_u32 s56, s9, s10
  s_add_u32 s57, s56, 4096
  s_cmp_lt_u32 s8, 64
  s_cselect_b32 s65, 1, 0
  s_cbranch_scc0 L_drain1
  s_mov_b64 exec, 1
  v_mov_b32 v225, 1
  buffer_atomic_add v225, v226, s[52:55], s62 offen sc0 sc1
  s_mov_b64 exec, -1
  buffer_load_dwordx4 v[128:131], v4, s[44:47], s56 offen offset:0 nt
  buffer_load_dwordx4 v[132:135], v4, s[44:47], s56 offen offset:64 nt
  buffer_load_dwordx4 v[136:139], v4, s[44:47], s56 offen offset:128 nt
  buffer_load_dwordx4 v[140:143], v4, s[44:47], s56 offen offset:192 nt
  buffer_load_dwordx4 v[144:147], v4, s[44:47], s57 offen offset:0 nt
  buffer_load_dwordx4 v[148:151], v4, s[44:47], s57 offen offset:64 nt
  buffer_load_dwordx4 v[152:155], v4, s[44:47], s57 offen offset:128 nt
  buffer_load_dwordx4 v[156:159], v4, s[44:47], s57 offen offset:192 nt
  v_cvt_pk_bf16_f32 v40, v32, v33
  v_cvt_pk_bf16_f32 v41, v34, v35
  v_cvt_pk_bf16_f32 v42, v36, v37
  v_cvt_pk_bf16_f32 v43, v38, v39
  v_lshlrev_b32 v32, 16, v40
  v_and_b32 v33, 0xffff0000, v40
  v_lshlrev_b32 v34, 16, v41
  v_and_b32 v35, 0xffff0000, v41
  v_lshlrev_b32 v36, 16, v42
  v_and_b32 v37, 0xffff0000, v42
  v_lshlrev_b32 v38, 16, v43
  v_and_b32 v39, 0xffff0000, v43
  v_mul_f32 v32, s69, v32
  v_mul_f32 v33, s69, v33
  v_mul_f32 v34, s69, v34
  v_mul_f32 v35, s69, v35
  v_mul_f32 v36, s69, v36
  v_mul_f32 v37, s69, v37
  v_mul_f32 v38, s69, v38
  v_mul_f32 v39, s69, v39
  v_cvt_pk_bf16_f32 v40, v32, v33
  v_cvt_pk_bf16_f32 v41, v34, v35
  v_cvt_pk_bf16_f32 v42, v36, v37
  v_cvt_pk_bf16_f32 v43, v38, v39
  v_lshlrev_b32 v32, 16, v40
  v_and_b32 v33, 0xffff0000, v40
  v_lshlrev_b32 v34, 16, v41
  v_and_b32 v35, 0xffff0000, v41
  v_lshlrev_b32 v36, 16, v42
  v_and_b32 v37, 0xffff0000, v42
  v_lshlrev_b32 v38, 16, v43
  v_and_b32 v39, 0xffff0000, v43
  v_max3_f32 v11, v32, v33, v34
  v_max3_f32 v11, v11, v35, v36
  v_max3_f32 v11, v11, v37, v38
  v_max3_f32 v11, v11, v39, v8
  v_mov_b32 v12, v11
  s_nop 1
  v_permlane16_swap_b32 v11, v12
  v_max_f32 v11, v11, v12
  v_mov_b32 v12, v11
  s_nop 1
  v_permlane32_swap_b32 v11, v12
  v_max_f32 v11, v11, v12
  v_cmp_gt_f32 vcc, v11, v8
  s_nop 4
  s_cbranch_vccz L_nors6
  v_sub_f32 v12, v8, v11
  v_mul_f32 v12, s58, v12
  v_exp_f32 v12, v12
  v_mov_b32 v8, v11
  v_mul_f32 v10, s58, v11
  v_sub_f32 v10, 0, v10
  v_mul_f32 v9, v9, v12
  v_mul_f32 v64, v64, v12
  v_mul_f32 v65, v65, v12
  v_mul_f32 v66, v66, v12
  v_mul_f32 v67, v67, v12
  v_mul_f32 v68, v68, v12
  v_mul_f32 v69, v69, v12
  v_mul_f32 v70, v70, v12
  v_mul_f32 v71, v71, v12
  v_mul_f32 v72, v72, v12
  v_mul_f32 v73, v73, v12
  v_mul_f32 v74, v74, v12
  v_mul_f32 v75, v75, v12
  v_mul_f32 v76, v76, v12
  v_mul_f32 v77, v77, v12
  v_mul_f32 v78, v78, v12
  v_mul_f32 v79, v79, v12
  v_mul_f32 v80, v80, v12
  v_mul_f32 v81, v81, v12
  v_mul_f32 v82, v82, v12
  v_mul_f32 v83, v83, v12
  v_mul_f32 v84, v84, v12
  v_mul_f32 v85, v85, v12
  v_mul_f32 v86, v86, v12
  v_mul_f32 v87, v87, v12
  v_mul_f32 v88, v88, v12
  v_mul_f32 v89, v89, v12
  v_mul_f32 v90, v90, v12
  v_mul_f32 v91, v91, v12
  v_mul_f32 v92, v92, v12
  v_mul_f32 v93, v93, v12
  v_mul_f32 v94, v94, v12
  v_mul_f32 v95, v95, v12
  s_nop 1
L_nors6:
  v_fma_f32 v32, v32, s58, v10
  v_fma_f32 v33, v33, s58, v10
  v_fma_f32 v34, v34, s58, v10
  v_fma_f32 v35, v35, s58, v10
  v_fma_f32 v36, v36, s58, v10
  v_fma_f32 v37, v37, s58, v10
  v_fma_f32 v38, v38, s58, v10
  v_fma_f32 v39, v39, s58, v10
  v_exp_f32 v32, v32
  v_exp_f32 v33, v33
  v_exp_f32 v34, v34
  v_exp_f32 v35, v35
  v_exp_f32 v36, v36
  v_exp_f32 v37, v37
  v_exp_f32 v38, v38
  v_exp_f32 v39, v39
  v_cvt_pk_bf16_f32 v40, v32, v33
  v_cvt_pk_bf16_f32 v41, v34, v35
  v_cvt_pk_bf16_f32 v42, v36, v37
  v_cvt_pk_bf16_f32 v43, v38, v39
  v_add_f32 v12, v32, v33
  v_add_f32 v13, v34, v35
  v_add_f32 v14, v36, v37
  v_add_f32 v15, v38, v39
  v_add_f32 v12, v12, v13
  v_add_f32 v14, v14, v15
  v_add_f32 v9, v9, v12
  v_add_f32 v9, v9, v14
  s_waitcnt vmcnt(26)
  v_perm_b32 v48, v196, v192, s59
  v_perm_b32 v49, v204, v200, s59
  v_perm_b32 v50, v212, v208, s59
  v_perm_b32 v51, v220, v216, s59
  v_perm_b32 v52, v196, v192, s60
  v_perm_b32 v53, v204, v200, s60
  v_perm_b32 v54, v212, v208, s60
  v_perm_b32 v55, v220, v216, s60
  v_mfma_f32_16x16x32_bf16 v[64:67], v[48:51], v[40:43], v[64:67]
  s_nop 0
  v_mfma_f32_16x16x32_bf16 v[68:71], v[52:55], v[40:43], v[68:71]
  v_perm_b32 v56, v197, v193, s59
  v_perm_b32 v57, v205, v201, s59
  v_perm_b32 v58, v213, v209, s59
  v_perm_b32 v59, v221, v217, s59
  v_perm_b32 v60, v197, v193, s60
  v_perm_b32 v61, v205, v201, s60
  v_perm_b32 v62, v213, v209, s60
  v_perm_b32 v63, v221, v217, s60
  v_mfma_f32_16x16x32_bf16 v[72:75], v[56:59], v[40:43], v[72:75]
  s_nop 0
  v_mfma_f32_16x16x32_bf16 v[76:79], v[60:63], v[40:43], v[76:79]
  v_perm_b32 v48, v198, v194, s59
  v_perm_b32 v49, v206, v202, s59
  v_perm_b32 v50, v214, v210, s59
  v_perm_b32 v51, v222, v218, s59
  v_perm_b32 v52, v198, v194, s60
  v_perm_b32 v53, v206, v202, s60
  v_perm_b32 v54, v214, v210, s60
  v_perm_b32 v55, v222, v218, s60
  v_mfma_f32_16x16x32_bf16 v[80:83], v[48:51], v[40:43], v[80:83]
  s_nop 0
  v_mfma_f32_16x16x32_bf16 v[84:87], v[52:55], v[40:43], v[84:87]
  v_perm_b32 v56, v199, v195, s59
  v_perm_b32 v57, v207, v203, s59
  v_perm_b32 v58, v215, v211, s59
  v_perm_b32 v59, v223, v219, s59
  v_perm_b32 v60, v199, v195, s60
  v_perm_b32 v61, v207, v203, s60
  v_perm_b32 v62, v215, v211, s60
  v_perm_b32 v63, v223, v219, s60
  v_mfma_f32_16x16x32_bf16 v[88:91], v[56:59], v[40:43], v[88:91]
  s_nop 0
  v_mfma_f32_16x16x32_bf16 v[92:95], v[60:63], v[40:43], v[92:95]
  buffer_load_dwordx4 v[192:195], v5, s[48:51], s56 offen offset:0 nt
  buffer_load_dwordx4 v[196:199], v5, s[48:51], s56 offen offset:256 nt
  buffer_load_dwordx4 v[200:203], v5, s[48:51], s56 offen offset:512 nt
  buffer_load_dwordx4 v[204:207], v5, s[48:51], s56 offen offset:768 nt
  buffer_load_dwordx4 v[208:211], v5, s[48:51], s57 offen offset:0 nt
  buffer_load_dwordx4 v[212:215], v5, s[48:51], s57 offen offset:256 nt
  buffer_load_dwordx4 v[216:219], v5, s[48:51], s57 offen offset:512 nt
  buffer_load_dwordx4 v[220:223], v5, s[48:51], s57 offen offset:768 nt
  s_branch L_dyn_loop
L_drain0:
  v_cvt_pk_bf16_f32 v40, v32, v33
  v_cvt_pk_bf16_f32 v41, v34, v35
  v_cvt_pk_bf16_f32 v42, v36, v37
  v_cvt_pk_bf16_f32 v43, v38, v39
  v_lshlrev_b32 v32, 16, v40
  v_and_b32 v33, 0xffff0000, v40
  v_lshlrev_b32 v34, 16, v41
  v_and_b32 v35, 0xffff0000, v41
  v_lshlrev_b32 v36, 16, v42
  v_and_b32 v37, 0xffff0000, v42
  v_lshlrev_b32 v38, 16, v43
  v_and_b32 v39, 0xffff0000, v43
  v_mul_f32 v32, s69, v32
  v_mul_f32 v33, s69, v33
  v_mul_f32 v34, s69, v34
  v_mul_f32 v35, s69, v35
  v_mul_f32 v36, s69, v36
  v_mul_f32 v37, s69, v37
  v_mul_f32 v38, s69, v38
  v_mul_f32 v39, s69, v39
  v_cvt_pk_bf16_f32 v40, v32, v33
  v_cvt_pk_bf16_f32 v41, v34, v35
  v_cvt_pk_bf16_f32 v42, v36, v37
  v_cvt_pk_bf16_f32 v43, v38, v39
  v_lshlrev_b32 v32, 16, v40
  v_and_b32 v33, 0xffff0000, v40
  v_lshlrev_b32 v34, 16, v41
  v_and_b32 v35, 0xffff0000, v41
  v_lshlrev_b32 v36, 16, v42
  v_and_b32 v37, 0xffff0000, v42
  v_lshlrev_b32 v38, 16, v43
  v_and_b32 v39, 0xffff0000, v43
  v_max3_f32 v11, v32, v33, v34
  v_max3_f32 v11, v11, v35, v36
  v_max3_f32 v11, v11, v37, v38
  v_max3_f32 v11, v11, v39, v8
  v_mov_b32 v12, v11
  s_nop 1
  v_permlane16_swap_b32 v11, v12
  v_max_f32 v11, v11, v12
  v_mov_b32 v12, v11
  s_nop 1
  v_permlane32_swap_b32 v11, v12
  v_max_f32 v11, v11, v12
  v_cmp_gt_f32 vcc, v11, v8
  s_nop 4
  s_cbranch_vccz L_nors7
  v_sub_f32 v12, v8, v11
  v_mul_f32 v12, s58, v12
  v_exp_f32 v12, v12
  v_mov_b32 v8, v11
  v_mul_f32 v10, s58, v11
  v_sub_f32 v10, 0, v10
  v_mul_f32 v9, v9, v12
  v_mul_f32 v64, v64, v12
  v_mul_f32 v65, v65, v12
  v_mul_f32 v66, v66, v12
  v_mul_f32 v67, v67, v12
  v_mul_f32 v68, v68, v12
  v_mul_f32 v69, v69, v12
  v_mul_f32 v70, v70, v12
  v_mul_f32 v71, v71, v12
  v_mul_f32 v72, v72, v12
  v_mul_f32 v73, v73, v12
  v_mul_f32 v74, v74, v12
  v_mul_f32 v75, v75, v12
  v_mul_f32 v76, v76, v12
  v_mul_f32 v77, v77, v12
  v_mul_f32 v78, v78, v12
  v_mul_f32 v79, v79, v12
  v_mul_f32 v80, v80, v12
  v_mul_f32 v81, v81, v12
  v_mul_f32 v82, v82, v12
  v_mul_f32 v83, v83, v12
  v_mul_f32 v84, v84, v12
  v_mul_f32 v85, v85, v12
  v_mul_f32 v86, v86, v12
  v_mul_f32 v87, v87, v12
  v_mul_f32 v88, v88, v12
  v_mul_f32 v89, v89, v12
  v_mul_f32 v90, v90, v12
  v_mul_f32 v91, v91, v12
  v_mul_f32 v92, v92, v12
  v_mul_f32 v93, v93, v12
  v_mul_f32 v94, v94, v12
  v_mul_f32 v95, v95, v12
  s_nop 1
L_nors7:
  v_fma_f32 v32, v32, s58, v10
  v_fma_f32 v33, v33, s58, v10
  v_fma_f32 v34, v34, s58, v10
  v_fma_f32 v35, v35, s58, v10
  v_fma_f32 v36, v36, s58, v10
  v_fma_f32 v37, v37, s58, v10
  v_fma_f32 v38, v38, s58, v10
  v_fma_f32 v39, v39, s58, v10
  v_exp_f32 v32, v32
  v_exp_f32 v33, v33
  v_exp_f32 v34, v34
  v_exp_f32 v35, v35
  v_exp_f32 v36, v36
  v_exp_f32 v37, v37
  v_exp_f32 v38, v38
  v_exp_f32 v39, v39
  v_cvt_pk_bf16_f32 v40, v32, v33
  v_cvt_pk_bf16_f32 v41, v34, v35
  v_cvt_pk_bf16_f32 v42, v36, v37
  v_cvt_pk_bf16_f32 v43, v38, v39
  v_add_f32 v12, v32, v33
  v_add_f32 v13, v34, v35
  v_add_f32 v14, v36, v37
  v_add_f32 v15, v38, v39
  v_add_f32 v12, v12, v13
  v_add_f32 v14, v14, v15
  v_add_f32 v9, v9, v12
  v_add_f32 v9, v9, v14
  s_waitcnt vmcnt(16)
  v_perm_b32 v48, v164, v160, s59
  v_perm_b32 v49, v172, v168, s59
  v_perm_b32 v50, v180, v176, s59
  v_perm_b32 v51, v188, v184, s59
  v_perm_b32 v52, v164, v160, s60
  v_perm_b32 v53, v172, v168, s60
  v_perm_b32 v54, v180, v176, s60
  v_perm_b32 v55, v188, v184, s60
  v_mfma_f32_16x16x32_bf16 v[64:67], v[48:51], v[40:43], v[64:67]
  s_nop 0
  v_mfma_f32_16x16x32_bf16 v[68:71], v[52:55], v[40:43], v[68:71]
  v_perm_b32 v56, v165, v161, s59
  v_perm_b32 v57, v173, v169, s59
  v_perm_b32 v58, v181, v177, s59
  v_perm_b32 v59, v189, v185, s59
  v_perm_b32 v60, v165, v161, s60
  v_perm_b32 v61, v173, v169, s60
  v_perm_b32 v62, v181, v177, s60
  v_perm_b32 v63, v189, v185, s60
  v_mfma_f32_16x16x32_bf16 v[72:75], v[56:59], v[40:43], v[72:75]
  s_nop 0
  v_mfma_f32_16x16x32_bf16 v[76:79], v[60:63], v[40:43], v[76:79]
  v_perm_b32 v48, v166, v162, s59
  v_perm_b32 v49, v174, v170, s59
  v_perm_b32 v50, v182, v178, s59
  v_perm_b32 v51, v190, v186, s59
  v_perm_b32 v52, v166, v162, s60
  v_perm_b32 v53, v174, v170, s60
  v_perm_b32 v54, v182, v178, s60
  v_perm_b32 v55, v190, v186, s60
  v_mfma_f32_16x16x32_bf16 v[80:83], v[48:51], v[40:43], v[80:83]
  s_nop 0
  v_mfma_f32_16x16x32_bf16 v[84:87], v[52:55], v[40:43], v[84:87]
  v_perm_b32 v56, v167, v163, s59
  v_perm_b32 v57, v175, v171, s59
  v_perm_b32 v58, v183, v179, s59
  v_perm_b32 v59, v191, v187, s59
  v_perm_b32 v60, v167, v163, s60
  v_perm_b32 v61, v175, v171, s60
  v_perm_b32 v62, v183, v179, s60
  v_perm_b32 v63, v191, v187, s60
  v_mfma_f32_16x16x32_bf16 v[88:91], v[56:59], v[40:43], v[88:91]
  s_nop 0
  v_mfma_f32_16x16x32_bf16 v[92:95], v[60:63], v[40:43], v[92:95]
  s_cmp_eq_u32 s65, 0
  s_nop 6
  s_cbranch_scc1 L_dyn_done
  s_waitcnt vmcnt(8)
  v_mfma_f32_16x16x32_bf16 v[32:35], v[128:131], v[16:19], 0
  v_mfma_f32_16x16x32_bf16 v[36:39], v[144:147], v[16:19], 0
  v_mfma_f32_16x16x32_bf16 v[32:35], v[132:135], v[20:23], v[32:35]
  v_mfma_f32_16x16x32_bf16 v[36:39], v[148:151], v[20:23], v[36:39]
  v_mfma_f32_16x16x32_bf16 v[32:35], v[136:139], v[24:27], v[32:35]
  v_mfma_f32_16x16x32_bf16 v[36:39], v[152:155], v[24:27], v[36:39]
  v_mfma_f32_16x16x32_bf16 v[32:35], v[140:143], v[28:31], v[32:35]
  v_mfma_f32_16x16x32_bf16 v[36:39], v[156:159], v[28:31], v[36:39]
  s_nop 6
  v_cvt_pk_bf16_f32 v40, v32, v33
  v_cvt_pk_bf16_f32 v41, v34, v35
  v_cvt_pk_bf16_f32 v42, v36, v37
  v_cvt_pk_bf16_f32 v43, v38, v39
  v_lshlrev_b32 v32, 16, v40
  v_and_b32 v33, 0xffff0000, v40
  v_lshlrev_b32 v34, 16, v41
  v_and_b32 v35, 0xffff0000, v41
  v_lshlrev_b32 v36, 16, v42
  v_and_b32 v37, 0xffff0000, v42
  v_lshlrev_b32 v38, 16, v43
  v_and_b32 v39, 0xffff0000, v43
  v_mul_f32 v32, s69, v32
  v_mul_f32 v33, s69, v33
  v_mul_f32 v34, s69, v34
  v_mul_f32 v35, s69, v35
  v_mul_f32 v36, s69, v36
  v_mul_f32 v37, s69, v37
  v_mul_f32 v38, s69, v38
  v_mul_f32 v39, s69, v39
  v_cvt_pk_bf16_f32 v40, v32, v33
  v_cvt_pk_bf16_f32 v41, v34, v35
  v_cvt_pk_bf16_f32 v42, v36, v37
  v_cvt_pk_bf16_f32 v43, v38, v39
  v_lshlrev_b32 v32, 16, v40
  v_and_b32 v33, 0xffff0000, v40
  v_lshlrev_b32 v34, 16, v41
  v_and_b32 v35, 0xffff0000, v41
  v_lshlrev_b32 v36, 16, v42
  v_and_b32 v37, 0xffff0000, v42
  v_lshlrev_b32 v38, 16, v43
  v_and_b32 v39, 0xffff0000, v43
  v_max3_f32 v11, v32, v33, v34
  v_max3_f32 v11, v11, v35, v36
  v_max3_f32 v11, v11, v37, v38
  v_max3_f32 v11, v11, v39, v8
  v_mov_b32 v12, v11
  s_nop 1
  v_permlane16_swap_b32 v11, v12
  v_max_f32 v11, v11, v12
  v_mov_b32 v12, v11
  s_nop 1
  v_permlane32_swap_b32 v11, v12
  v_max_f32 v11, v11, v12
  v_cmp_gt_f32 vcc, v11, v8
  s_nop 4
  s_cbranch_vccz L_nors8
  v_sub_f32 v12, v8, v11
  v_mul_f32 v12, s58, v12
  v_exp_f32 v12, v12
  v_mov_b32 v8, v11
  v_mul_f32 v10, s58, v11
  v_sub_f32 v10, 0, v10
  v_mul_f32 v9, v9, v12
  v_mul_f32 v64, v64, v12
  v_mul_f32 v65, v65, v12
  v_mul_f32 v66, v66, v12
  v_mul_f32 v67, v67, v12
  v_mul_f32 v68, v68, v12
  v_mul_f32 v69, v69, v12
  v_mul_f32 v70, v70, v12
  v_mul_f32 v71, v71, v12
  v_mul_f32 v72, v72, v12
  v_mul_f32 v73, v73, v12
  v_mul_f32 v74, v74, v12
  v_mul_f32 v75, v75, v12
  v_mul_f32 v76, v76, v12
  v_mul_f32 v77, v77, v12
  v_mul_f32 v78, v78, v12
  v_mul_f32 v79, v79, v12
  v_mul_f32 v80, v80, v12
  v_mul_f32 v81, v81, v12
  v_mul_f32 v82, v82, v12
  v_mul_f32 v83, v83, v12
  v_mul_f32 v84, v84, v12
  v_mul_f32 v85, v85, v12
  v_mul_f32 v86, v86, v12
  v_mul_f32 v87, v87, v12
  v_mul_f32 v88, v88, v12
  v_mul_f32 v89, v89, v12
  v_mul_f32 v90, v90, v12
  v_mul_f32 v91, v91, v12
  v_mul_f32 v92, v92, v12
  v_mul_f32 v93, v93, v12
  v_mul_f32 v94, v94, v12
  v_mul_f32 v95, v95, v12
  s_nop 1
L_nors8:
  v_fma_f32 v32, v32, s58, v10
  v_fma_f32 v33, v33, s58, v10
  v_fma_f32 v34, v34, s58, v10
  v_fma_f32 v35, v35, s58, v10
  v_fma_f32 v36, v36, s58, v10
  v_fma_f32 v37, v37, s58, v10
  v_fma_f32 v38, v38, s58, v10
  v_fma_f32 v39, v39, s58, v10
  v_exp_f32 v32, v32
  v_exp_f32 v33, v33
  v_exp_f32 v34, v34
  v_exp_f32 v35, v35
  v_exp_f32 v36, v36
  v_exp_f32 v37, v37
  v_exp_f32 v38, v38
  v_exp_f32 v39, v39
  v_cvt_pk_bf16_f32 v40, v32, v33
  v_cvt_pk_bf16_f32 v41, v34, v35
  v_cvt_pk_bf16_f32 v42, v36, v37
  v_cvt_pk_bf16_f32 v43, v38, v39
  v_add_f32 v12, v32, v33
  v_add_f32 v13, v34, v35
  v_add_f32 v14, v36, v37
  v_add_f32 v15, v38, v39
  v_add_f32 v12, v12, v13
  v_add_f32 v14, v14, v15
  v_add_f32 v9, v9, v12
  v_add_f32 v9, v9, v14
  s_waitcnt vmcnt(0)
  v_perm_b32 v48, v196, v192, s59
  v_perm_b32 v49, v204, v200, s59
  v_perm_b32 v50, v212, v208, s59
  v_perm_b32 v51, v220, v216, s59
  v_perm_b32 v52, v196, v192, s60
  v_perm_b32 v53, v204, v200, s60
  v_perm_b32 v54, v212, v208, s60
  v_perm_b32 v55, v220, v216, s60
  v_mfma_f32_16x16x32_bf16 v[64:67], v[48:51], v[40:43], v[64:67]
  s_nop 0
  v_mfma_f32_16x16x32_bf16 v[68:71], v[52:55], v[40:43], v[68:71]
  v_perm_b32 v56, v197, v193, s59
  v_perm_b32 v57, v205, v201, s59
  v_perm_b32 v58, v213, v209, s59
  v_perm_b32 v59, v221, v217, s59
  v_perm_b32 v60, v197, v193, s60
  v_perm_b32 v61, v205, v201, s60
  v_perm_b32 v62, v213, v209, s60
  v_perm_b32 v63, v221, v217, s60
  v_mfma_f32_16x16x32_bf16 v[72:75], v[56:59], v[40:43], v[72:75]
  s_nop 0
  v_mfma_f32_16x16x32_bf16 v[76:79], v[60:63], v[40:43], v[76:79]
  v_perm_b32 v48, v198, v194, s59
  v_perm_b32 v49, v206, v202, s59
  v_perm_b32 v50, v214, v210, s59
  v_perm_b32 v51, v222, v218, s59
  v_perm_b32 v52, v198, v194, s60
  v_perm_b32 v53, v206, v202, s60
  v_perm_b32 v54, v214, v210, s60
  v_perm_b32 v55, v222, v218, s60
  v_mfma_f32_16x16x32_bf16 v[80:83], v[48:51], v[40:43], v[80:83]
  s_nop 0
  v_mfma_f32_16x16x32_bf16 v[84:87], v[52:55], v[40:43], v[84:87]
  v_perm_b32 v56, v199, v195, s59
  v_perm_b32 v57, v207, v203, s59
  v_perm_b32 v58, v215, v211, s59
  v_perm_b32 v59, v223, v219, s59
  v_perm_b32 v60, v199, v195, s60
  v_perm_b32 v61, v207, v203, s60
  v_perm_b32 v62, v215, v211, s60
  v_perm_b32 v63, v223, v219, s60
  v_mfma_f32_16x16x32_bf16 v[88:91], v[56:59], v[40:43], v[88:91]
  s_nop 0
  v_mfma_f32_16x16x32_bf16 v[92:95], v[60:63], v[40:43], v[92:95]
  s_nop 7
  s_branch L_dyn_done
L_drain1:
  v_cvt_pk_bf16_f32 v40, v32, v33
  v_cvt_pk_bf16_f32 v41, v34, v35
  v_cvt_pk_bf16_f32 v42, v36, v37
  v_cvt_pk_bf16_f32 v43, v38, v39
  v_lshlrev_b32 v32, 16, v40
  v_and_b32 v33, 0xffff0000, v40
  v_lshlrev_b32 v34, 16, v41
  v_and_b32 v35, 0xffff0000, v41
  v_lshlrev_b32 v36, 16, v42
  v_and_b32 v37, 0xffff0000, v42
  v_lshlrev_b32 v38, 16, v43
  v_and_b32 v39, 0xffff0000, v43
  v_mul_f32 v32, s69, v32
  v_mul_f32 v33, s69, v33
  v_mul_f32 v34, s69, v34
  v_mul_f32 v35, s69, v35
  v_mul_f32 v36, s69, v36
  v_mul_f32 v37, s69, v37
  v_mul_f32 v38, s69, v38
  v_mul_f32 v39, s69, v39
  v_cvt_pk_bf16_f32 v40, v32, v33
  v_cvt_pk_bf16_f32 v41, v34, v35
  v_cvt_pk_bf16_f32 v42, v36, v37
  v_cvt_pk_bf16_f32 v43, v38, v39
  v_lshlrev_b32 v32, 16, v40
  v_and_b32 v33, 0xffff0000, v40
  v_lshlrev_b32 v34, 16, v41
  v_and_b32 v35, 0xffff0000, v41
  v_lshlrev_b32 v36, 16, v42
  v_and_b32 v37, 0xffff0000, v42
  v_lshlrev_b32 v38, 16, v43
  v_and_b32 v39, 0xffff0000, v43
  v_max3_f32 v11, v32, v33, v34
  v_max3_f32 v11, v11, v35, v36
  v_max3_f32 v11, v11, v37, v38
  v_max3_f32 v11, v11, v39, v8
  v_mov_b32 v12, v11
  s_nop 1
  v_permlane16_swap_b32 v11, v12
  v_max_f32 v11, v11, v12
  v_mov_b32 v12, v11
  s_nop 1
  v_permlane32_swap_b32 v11, v12
  v_max_f32 v11, v11, v12
  v_cmp_gt_f32 vcc, v11, v8
  s_nop 4
  s_cbranch_vccz L_nors9
  v_sub_f32 v12, v8, v11
  v_mul_f32 v12, s58, v12
  v_exp_f32 v12, v12
  v_mov_b32 v8, v11
  v_mul_f32 v10, s58, v11
  v_sub_f32 v10, 0, v10
  v_mul_f32 v9, v9, v12
  v_mul_f32 v64, v64, v12
  v_mul_f32 v65, v65, v12
  v_mul_f32 v66, v66, v12
  v_mul_f32 v67, v67, v12
  v_mul_f32 v68, v68, v12
  v_mul_f32 v69, v69, v12
  v_mul_f32 v70, v70, v12
  v_mul_f32 v71, v71, v12
  v_mul_f32 v72, v72, v12
  v_mul_f32 v73, v73, v12
  v_mul_f32 v74, v74, v12
  v_mul_f32 v75, v75, v12
  v_mul_f32 v76, v76, v12
  v_mul_f32 v77, v77, v12
  v_mul_f32 v78, v78, v12
  v_mul_f32 v79, v79, v12
  v_mul_f32 v80, v80, v12
  v_mul_f32 v81, v81, v12
  v_mul_f32 v82, v82, v12
  v_mul_f32 v83, v83, v12
  v_mul_f32 v84, v84, v12
  v_mul_f32 v85, v85, v12
  v_mul_f32 v86, v86, v12
  v_mul_f32 v87, v87, v12
  v_mul_f32 v88, v88, v12
  v_mul_f32 v89, v89, v12
  v_mul_f32 v90, v90, v12
  v_mul_f32 v91, v91, v12
  v_mul_f32 v92, v92, v12
  v_mul_f32 v93, v93, v12
  v_mul_f32 v94, v94, v12
  v_mul_f32 v95, v95, v12
  s_nop 1
L_nors9:
  v_fma_f32 v32, v32, s58, v10
  v_fma_f32 v33, v33, s58, v10
  v_fma_f32 v34, v34, s58, v10
  v_fma_f32 v35, v35, s58, v10
  v_fma_f32 v36, v36, s58, v10
  v_fma_f32 v37, v37, s58, v10
  v_fma_f32 v38, v38, s58, v10
  v_fma_f32 v39, v39, s58, v10
  v_exp_f32 v32, v32
  v_exp_f32 v33, v33
  v_exp_f32 v34, v34
  v_exp_f32 v35, v35
  v_exp_f32 v36, v36
  v_exp_f32 v37, v37
  v_exp_f32 v38, v38
  v_exp_f32 v39, v39
  v_cvt_pk_bf16_f32 v40, v32, v33
  v_cvt_pk_bf16_f32 v41, v34, v35
  v_cvt_pk_bf16_f32 v42, v36, v37
  v_cvt_pk_bf16_f32 v43, v38, v39
  v_add_f32 v12, v32, v33
  v_add_f32 v13, v34, v35
  v_add_f32 v14, v36, v37
  v_add_f32 v15, v38, v39
  v_add_f32 v12, v12, v13
  v_add_f32 v14, v14, v15
  v_add_f32 v9, v9, v12
  v_add_f32 v9, v9, v14
  s_waitcnt vmcnt(16)
  v_perm_b32 v48, v196, v192, s59
  v_perm_b32 v49, v204, v200, s59
  v_perm_b32 v50, v212, v208, s59
  v_perm_b32 v51, v220, v216, s59
  v_perm_b32 v52, v196, v192, s60
  v_perm_b32 v53, v204, v200, s60
  v_perm_b32 v54, v212, v208, s60
  v_perm_b32 v55, v220, v216, s60
  v_mfma_f32_16x16x32_bf16 v[64:67], v[48:51], v[40:43], v[64:67]
  s_nop 0
  v_mfma_f32_16x16x32_bf16 v[68:71], v[52:55], v[40:43], v[68:71]
  v_perm_b32 v56, v197, v193, s59
  v_perm_b32 v57, v205, v201, s59
  v_perm_b32 v58, v213, v209, s59
  v_perm_b32 v59, v221, v217, s59
  v_perm_b32 v60, v197, v193, s60
  v_perm_b32 v61, v205, v201, s60
  v_perm_b32 v62, v213, v209, s60
  v_perm_b32 v63, v221, v217, s60
  v_mfma_f32_16x16x32_bf16 v[72:75], v[56:59], v[40:43], v[72:75]
  s_nop 0
  v_mfma_f32_16x16x32_bf16 v[76:79], v[60:63], v[40:43], v[76:79]
  v_perm_b32 v48, v198, v194, s59
  v_perm_b32 v49, v206, v202, s59
  v_perm_b32 v50, v214, v210, s59
  v_perm_b32 v51, v222, v218, s59
  v_perm_b32 v52, v198, v194, s60
  v_perm_b32 v53, v206, v202, s60
  v_perm_b32 v54, v214, v210, s60
  v_perm_b32 v55, v222, v218, s60
  v_mfma_f32_16x16x32_bf16 v[80:83], v[48:51], v[40:43], v[80:83]
  s_nop 0
  v_mfma_f32_16x16x32_bf16 v[84:87], v[52:55], v[40:43], v[84:87]
  v_perm_b32 v56, v199, v195, s59
  v_perm_b32 v57, v207, v203, s59
  v_perm_b32 v58, v215, v211, s59
  v_perm_b32 v59, v223, v219, s59
  v_perm_b32 v60, v199, v195, s60
  v_perm_b32 v61, v207, v203, s60
  v_perm_b32 v62, v215, v211, s60
  v_perm_b32 v63, v223, v219, s60
  v_mfma_f32_16x16x32_bf16 v[88:91], v[56:59], v[40:43], v[88:91]
  s_nop 0
  v_mfma_f32_16x16x32_bf16 v[92:95], v[60:63], v[40:43], v[92:95]
  s_cmp_eq_u32 s64, 0
  s_nop 6
  s_cbranch_scc1 L_dyn_done
  s_waitcnt vmcnt(8)
  v_mfma_f32_16x16x32_bf16 v[32:35], v[96:99], v[16:19], 0
  v_mfma_f32_16x16x32_bf16 v[36:39], v[112:115], v[16:19], 0
  v_mfma_f32_16x16x32_bf16 v[32:35], v[100:103], v[20:23], v[32:35]
  v_mfma_f32_16x16x32_bf16 v[36:39], v[116:119], v[20:23], v[36:39]
  v_mfma_f32_16x16x32_bf16 v[32:35], v[104:107], v[24:27], v[32:35]
  v_mfma_f32_16x16x32_bf16 v[36:39], v[120:123], v[24:27], v[36:39]
  v_mfma_f32_16x16x32_bf16 v[32:35], v[108:111], v[28:31], v[32:35]
  v_mfma_f32_16x16x32_bf16 v[36:39], v[124:127], v[28:31], v[36:39]
  s_nop 6
  v_cvt_pk_bf16_f32 v40, v32, v33
  v_cvt_pk_bf16_f32 v41, v34, v35
  v_cvt_pk_bf16_f32 v42, v36, v37
  v_cvt_pk_bf16_f32 v43, v38, v39
  v_lshlrev_b32 v32, 16, v40
  v_and_b32 v33, 0xffff0000, v40
  v_lshlrev_b32 v34, 16, v41
  v_and_b32 v35, 0xffff0000, v41
  v_lshlrev_b32 v36, 16, v42
  v_and_b32 v37, 0xffff0000, v42
  v_lshlrev_b32 v38, 16, v43
  v_and_b32 v39, 0xffff0000, v43
  v_mul_f32 v32, s69, v32
  v_mul_f32 v33, s69, v33
  v_mul_f32 v34, s69, v34
  v_mul_f32 v35, s69, v35
  v_mul_f32 v36, s69, v36
  v_mul_f32 v37, s69, v37
  v_mul_f32 v38, s69, v38
  v_mul_f32 v39, s69, v39
  v_cvt_pk_bf16_f32 v40, v32, v33
  v_cvt_pk_bf16_f32 v41, v34, v35
  v_cvt_pk_bf16_f32 v42, v36, v37
  v_cvt_pk_bf16_f32 v43, v38, v39
  v_lshlrev_b32 v32, 16, v40
  v_and_b32 v33, 0xffff0000, v40
  v_lshlrev_b32 v34, 16, v41
  v_and_b32 v35, 0xffff0000, v41
  v_lshlrev_b32 v36, 16, v42
  v_and_b32 v37, 0xffff0000, v42
  v_lshlrev_b32 v38, 16, v43
  v_and_b32 v39, 0xffff0000, v43
  v_max3_f32 v11, v32, v33, v34
  v_max3_f32 v11, v11, v35, v36
  v_max3_f32 v11, v11, v37, v38
  v_max3_f32 v11, v11, v39, v8
  v_mov_b32 v12, v11
  s_nop 1
  v_permlane16_swap_b32 v11, v12
  v_max_f32 v11, v11, v12
  v_mov_b32 v12, v11
  s_nop 1
  v_permlane32_swap_b32 v11, v12
  v_max_f32 v11, v11, v12
  v_cmp_gt_f32 vcc, v11, v8
  s_nop 4
  s_cbranch_vccz L_nors10
  v_sub_f32 v12, v8, v11
  v_mul_f32 v12, s58, v12
  v_exp_f32 v12, v12
  v_mov_b32 v8, v11
  v_mul_f32 v10, s58, v11
  v_sub_f32 v10, 0, v10
  v_mul_f32 v9, v9, v12
  v_mul_f32 v64, v64, v12
  v_mul_f32 v65, v65, v12
  v_mul_f32 v66, v66, v12
  v_mul_f32 v67, v67, v12
  v_mul_f32 v68, v68, v12
  v_mul_f32 v69, v69, v12
  v_mul_f32 v70, v70, v12
  v_mul_f32 v71, v71, v12
  v_mul_f32 v72, v72, v12
  v_mul_f32 v73, v73, v12
  v_mul_f32 v74, v74, v12
  v_mul_f32 v75, v75, v12
  v_mul_f32 v76, v76, v12
  v_mul_f32 v77, v77, v12
  v_mul_f32 v78, v78, v12
  v_mul_f32 v79, v79, v12
  v_mul_f32 v80, v80, v12
  v_mul_f32 v81, v81, v12
  v_mul_f32 v82, v82, v12
  v_mul_f32 v83, v83, v12
  v_mul_f32 v84, v84, v12
  v_mul_f32 v85, v85, v12
  v_mul_f32 v86, v86, v12
  v_mul_f32 v87, v87, v12
  v_mul_f32 v88, v88, v12
  v_mul_f32 v89, v89, v12
  v_mul_f32 v90, v90, v12
  v_mul_f32 v91, v91, v12
  v_mul_f32 v92, v92, v12
  v_mul_f32 v93, v93, v12
  v_mul_f32 v94, v94, v12
  v_mul_f32 v95, v95, v12
  s_nop 1
L_nors10:
  v_fma_f32 v32, v32, s58, v10
  v_fma_f32 v33, v33, s58, v10
  v_fma_f32 v34, v34, s58, v10
  v_fma_f32 v35, v35, s58, v10
  v_fma_f32 v36, v36, s58, v10
  v_fma_f32 v37, v37, s58, v10
  v_fma_f32 v38, v38, s58, v10
  v_fma_f32 v39, v39, s58, v10
  v_exp_f32 v32, v32
  v_exp_f32 v33, v33
  v_exp_f32 v34, v34
  v_exp_f32 v35, v35
  v_exp_f32 v36, v36
  v_exp_f32 v37, v37
  v_exp_f32 v38, v38
  v_exp_f32 v39, v39
  v_cvt_pk_bf16_f32 v40, v32, v33
  v_cvt_pk_bf16_f32 v41, v34, v35
  v_cvt_pk_bf16_f32 v42, v36, v37
  v_cvt_pk_bf16_f32 v43, v38, v39
  v_add_f32 v12, v32, v33
  v_add_f32 v13, v34, v35
  v_add_f32 v14, v36, v37
  v_add_f32 v15, v38, v39
  v_add_f32 v12, v12, v13
  v_add_f32 v14, v14, v15
  v_add_f32 v9, v9, v12
  v_add_f32 v9, v9, v14
  s_waitcnt vmcnt(0)
  v_perm_b32 v48, v164, v160, s59
  v_perm_b32 v49, v172, v168, s59
  v_perm_b32 v50, v180, v176, s59
  v_perm_b32 v51, v188, v184, s59
  v_perm_b32 v52, v164, v160, s60
  v_perm_b32 v53, v172, v168, s60
  v_perm_b32 v54, v180, v176, s60
  v_perm_b32 v55, v188, v184, s60
  v_mfma_f32_16x16x32_bf16 v[64:67], v[48:51], v[40:43], v[64:67]
  s_nop 0
  v_mfma_f32_16x16x32_bf16 v[68:71], v[52:55], v[40:43], v[68:71]
  v_perm_b32 v56, v165, v161, s59
  v_perm_b32 v57, v173, v169, s59
  v_perm_b32 v58, v181, v177, s59
  v_perm_b32 v59, v189, v185, s59
  v_perm_b32 v60, v165, v161, s60
  v_perm_b32 v61, v173, v169, s60
  v_perm_b32 v62, v181, v177, s60
  v_perm_b32 v63, v189, v185, s60
  v_mfma_f32_16x16x32_bf16 v[72:75], v[56:59], v[40:43], v[72:75]
  s_nop 0
  v_mfma_f32_16x16x32_bf16 v[76:79], v[60:63], v[40:43], v[76:79]
  v_perm_b32 v48, v166, v162, s59
  v_perm_b32 v49, v174, v170, s59
  v_perm_b32 v50, v182, v178, s59
  v_perm_b32 v51, v190, v186, s59
  v_perm_b32 v52, v166, v162, s60
  v_perm_b32 v53, v174, v170, s60
  v_perm_b32 v54, v182, v178, s60
  v_perm_b32 v55, v190, v186, s60
  v_mfma_f32_16x16x32_bf16 v[80:83], v[48:51], v[40:43], v[80:83]
  s_nop 0
  v_mfma_f32_16x16x32_bf16 v[84:87], v[52:55], v[40:43], v[84:87]
  v_perm_b32 v56, v167, v163, s59
  v_perm_b32 v57, v175, v171, s59
  v_perm_b32 v58, v183, v179, s59
  v_perm_b32 v59, v191, v187, s59
  v_perm_b32 v60, v167, v163, s60
  v_perm_b32 v61, v175, v171, s60
  v_perm_b32 v62, v183, v179, s60
  v_perm_b32 v63, v191, v187, s60
  v_mfma_f32_16x16x32_bf16 v[88:91], v[56:59], v[40:43], v[88:91]
  s_nop 0
  v_mfma_f32_16x16x32_bf16 v[92:95], v[60:63], v[40:43], v[92:95]
  s_nop 7
L_dyn_done:
  v_mov_b32 v12, v9
  s_nop 1
  v_permlane16_swap_b32 v9, v12
  v_add_f32 v9, v9, v12
  v_mov_b32 v12, v9
  s_nop 1
  v_permlane32_swap_b32 v9, v12
  v_add_f32 v9, v9, v12
  s_lshl_b32 s8, s3, 10
  v_and_b32 v6, 1, v2
  v_lshlrev_b32 v6, 9, v6
  v_lshl_add_u32 v6, v3, 7, v6
  v_add_u32 v6, s8, v6
  s_lshl_b32 s8, s3, 4
  v_lshlrev_b32 v7, 3, v2
  v_add_u32 v7, s8, v7
  v_add_u32 v6, 5120, v6
  s_mov_b32 exec_lo, 0x00030003
  s_mov_b32 exec_hi, 0x00030003
  ds_write2_b32 v6, v64, v68 offset0:0 offset1:1
  ds_write2_b32 v6, v72, v76 offset0:2 offset1:3
  ds_write2_b32 v6, v80, v84 offset0:4 offset1:5
  ds_write2_b32 v6, v88, v92 offset0:6 offset1:7
  ds_write2_b32 v6, v65, v69 offset0:8 offset1:9
  ds_write2_b32 v6, v73, v77 offset0:10 offset1:11
  ds_write2_b32 v6, v81, v85 offset0:12 offset1:13
  ds_write2_b32 v6, v89, v93 offset0:14 offset1:15
  ds_write2_b32 v6, v66, v70 offset0:16 offset1:17
  ds_write2_b32 v6, v74, v78 offset0:18 offset1:19
  ds_write2_b32 v6, v82, v86 offset0:20 offset1:21
  ds_write2_b32 v6, v90, v94 offset0:22 offset1:23
  ds_write2_b32 v6, v67, v71 offset0:24 offset1:25
  ds_write2_b32 v6, v75, v79 offset0:26 offset1:27
  ds_write2_b32 v6, v83, v87 offset0:28 offset1:29
  ds_write2_b32 v6, v91, v95 offset0:30 offset1:31
  s_mov_b64 exec, 3
  ds_write_b64 v7, v[8:9] offset:9216
  s_waitcnt lgkmcnt(0)
  s_barrier
  s_endpgm
L_aux2:
  s_lshl_b32 s10, s4, 8
  s_lshl_b32 s11, s5, 7
  s_add_u32 s10, s10, s11
  s_lshl_b32 s11, s3, 5
  s_add_u32 s10, s10, s11
  s_mul_i32 s66, s10, 1152
  s_lshl_b32 s11, s61, 7
  s_add_u32 s66, s66, s11
  s_mul_i32 s10, s4, 288
  s_mul_i32 s14, s5, 144
  s_add_u32 s10, s10, s14
  s_lshl_b32 s14, s3, 5
  s_add_u32 s63, s10, s14
  s_mul_i32 s67, s63, 1152
  s_add_u32 s67, s67, s11
  s_mov_b32 s68, 0x00ff00ff
  s_cmp_eq_u32 s61, 7
  s_cselect_b32 s68, -1, s68
  s_mov_b32 s69, s68
  s_mov_b32 s94, 4718592
  s_mov_b32 s95, 0x20000
  s_mov_b32 s98, 5308416
  s_mov_b32 s99, 0x20000
  s_mov_b32 s92, s24
  s_mov_b32 s93, s25
  s_mov_b32 s96, s32
  s_mov_b32 s97, s33
  v_mul_u32_u24 v36, 9216, v3
  v_lshl_add_u32 v36, v2, 4, v36
  v_add_u32 v37, 1152, v36
  v_add_u32 v38, 2304, v36
  v_add_u32 v39, 3456, v36
  v_add_u32 v40, 4608, v36
  v_add_u32 v41, 5760, v36
  v_add_u32 v42, 6912, v36
  v_add_u32 v43, 8064, v36
  s_cmp_eq_u32 s3, 0
  s_nop 0
  s_cbranch_scc0 L_lt1
  s_mov_b64 exec, s[68:69]
  buffer_load_dwordx4 v[224:227], v36, s[92:95], s66 offen nt
  buffer_load_dwordx4 v[228:231], v37, s[92:95], s66 offen nt
  buffer_load_dwordx4 v[232:235], v38, s[92:95], s66 offen nt
  buffer_load_dwordx4 v[236:239], v39, s[92:95], s66 offen nt
  buffer_load_dwordx4 v[240:243], v40, s[92:95], s66 offen nt
  buffer_load_dwordx4 v[244:247], v41, s[92:95], s66 offen nt
  buffer_load_dwordx4 v[248:251], v42, s[92:95], s66 offen nt
  buffer_load_dwordx4 v[252:255], v43, s[92:95], s66 offen nt
  buffer_load_dwordx4 v[192:195], v36, s[96:99], s67 offen nt
  buffer_load_dwordx4 v[196:199], v37, s[96:99], s67 offen nt
  buffer_load_dwordx4 v[200:203], v38, s[96:99], s67 offen nt
  buffer_load_dwordx4 v[204:207], v39, s[96:99], s67 offen nt
  buffer_load_dwordx4 v[208:211], v40, s[96:99], s67 offen nt
  buffer_load_dwordx4 v[212:215], v41, s[96:99], s67 offen nt
  buffer_load_dwordx4 v[216:219], v42, s[96:99], s67 offen nt
  buffer_load_dwordx4 v[220:223], v43, s[96:99], s67 offen nt
  s_mov_b64 exec, -1
  v_mov_b32 v44, 0x40000000
  v_cmp_gt_u32 vcc, 32, v0
  s_add_u32 s14, s67, 147456
  s_mov_b64 exec, s[68:69]
  v_cndmask_b32 v45, v44, v36, vcc
  buffer_load_dwordx4 v[128:131], v45, s[96:99], s14 offen nt
  v_cndmask_b32 v45, v44, v37, vcc
  buffer_load_dwordx4 v[132:135], v45, s[96:99], s14 offen nt
  v_cndmask_b32 v45, v44, v38, vcc
  buffer_load_dwordx4 v[136:139], v45, s[96:99], s14 offen nt
  v_cndmask_b32 v45, v44, v39, vcc
  buffer_load_dwordx4 v[140:143], v45, s[96:99], s14 offen nt
  v_cndmask_b32 v45, v44, v40, vcc
  buffer_load_dwordx4 v[144:147], v45, s[96:99], s14 offen nt
  v_cndmask_b32 v45, v44, v41, vcc
  buffer_load_dwordx4 v[148:151], v45, s[96:99], s14 offen nt
  v_cndmask_b32 v45, v44, v42, vcc
  buffer_load_dwordx4 v[152:155], v45, s[96:99], s14 offen nt
  v_cndmask_b32 v45, v44, v43, vcc
  buffer_load_dwordx4 v[156:159], v45, s[96:99], s14 offen nt
  s_mov_b64 exec, -1
  s_branch L_lt2
L_lt1:
  s_mov_b64 exec, s[68:69]
  buffer_load_dwordx4 v[224:227], v36, s[92:95], s66 offen nt
  buffer_load_dwordx4 v[228:231], v37, s[92:95], s66 offen nt
  buffer_load_dwordx4 v[232:235], v38, s[92:95], s66 offen nt
  buffer_load_dwordx4 v[236:239], v39, s[92:95], s66 offen nt
  buffer_load_dwordx4 v[240:243], v40, s[92:95], s66 offen nt
  buffer_load_dwordx4 v[244:247], v41, s[92:95], s66 offen nt
  buffer_load_dwordx4 v[248:251], v42, s[92:95], s66 offen nt
  buffer_load_dwordx4 v[252:255], v43, s[92:95], s66 offen nt
  buffer_load_dwordx4 v[192:195], v36, s[96:99], s67 offen nt
  buffer_load_dwordx4 v[196:199], v37, s[96:99], s67 offen nt
  buffer_load_dwordx4 v[200:203], v38, s[96:99], s67 offen nt
  buffer_load_dwordx4 v[204:207], v39, s[96:99], s67 offen nt
  buffer_load_dwordx4 v[208:211], v40, s[96:99], s67 offen nt
  buffer_load_dwordx4 v[212:215], v41, s[96:99], s67 offen nt
  buffer_load_dwordx4 v[216:219], v42, s[96:99], s67 offen nt
  buffer_load_dwordx4 v[220:223], v43, s[96:99], s67 offen nt
  s_mov_b64 exec, -1
L_lt2:
  s_waitcnt vmcnt(0)
  v_perm_b32 v160, v228, v224, s59
  v_perm_b32 v161, v236, v232, s59
  v_perm_b32 v162, v244, v240, s59
  v_perm_b32 v163, v252, v248, s59
  v_perm_b32 v164, v228, v224, s60
  v_perm_b32 v165, v236, v232, s60
  v_perm_b32 v166, v244, v240, s60
  v_perm_b32 v167, v252, v248, s60
  v_perm_b32 v168, v229, v225, s59
  v_perm_b32 v169, v237, v233, s59
  v_perm_b32 v170, v245, v241, s59
  v_perm_b32 v171, v253, v249, s59
  v_perm_b32 v172, v229, v225, s60
  v_perm_b32 v173, v237, v233, s60
  v_perm_b32 v174, v245, v241, s60
  v_perm_b32 v175, v253, v249, s60
  v_perm_b32 v176, v230, v226, s59
  v_perm_b32 v177, v238, v234, s59
  v_perm_b32 v178, v246, v242, s59
  v_perm_b32 v179, v254, v250, s59
  v_perm_b32 v180, v230, v226, s60
  v_perm_b32 v181, v238, v234, s60
  v_perm_b32 v182, v246, v242, s60
  v_perm_b32 v183, v254, v250, s60
  v_perm_b32 v184, v231, v227, s59
  v_perm_b32 v185, v239, v235, s59
  v_perm_b32 v186, v247, v243, s59
  v_perm_b32 v187, v255, v251, s59
  v_perm_b32 v188, v231, v227, s60
  v_perm_b32 v189, v239, v235, s60
  v_perm_b32 v190, v247, v243, s60
  v_perm_b32 v191, v255, v251, s60
  s_cmp_lg_u32 s3, 0
  s_nop 0
  s_cbranch_scc1 L_allwait
  v_lshlrev_b32 v4, 4, v2
  s_mov_b32 s12, 65536
  s_nop 0
L_all_poll:
  global_load_dword v30, v4, s[38:39] sc1
  s_waitcnt vmcnt(0)
  v_cmp_gt_u32 vcc, 16, v30
  s_nop 4
  s_cbranch_vccz L_all_ok
  s_sleep 16
  s_sub_u32 s12, s12, 1
  s_cmp_lg_u32 s12, 0
  s_cbranch_scc1 L_all_poll
L_all_ok:
  v_mov_b32 v30, 512
  v_mov_b32 v31, 1
  ds_write_b32 v30, v31 offset:4
  s_nop 0
  s_branch L_alldone
L_allwait:
  s_mov_b32 s12, 65536
L_allw_poll:
  v_mov_b32 v30, 512
  ds_read_b32 v31, v30 offset:4
  s_waitcnt lgkmcnt(0)
  v_readfirstlane_b32 s8, v31
  s_nop 0
  s_cmp_eq_u32 s8, 1
  s_nop 2
  s_cbranch_scc1 L_allw_ok
  s_sleep 4
  s_sub_u32 s12, s12, 1
  s_cmp_lg_u32 s12, 0
  s_cbranch_scc1 L_allw_poll
L_allw_ok:
L_alldone:
  v_lshrrev_b32 v4, 5, v0
  v_mul_u32_u24 v4, 18432, v4
  v_and_b32 v5, 31, v0
  v_lshl_add_u32 v4, v5, 2, v4
  s_lshl_b32 s8, s63, 2
  s_add_u32 s8, s8, 425984
  s_add_u32 s9, s8, 36864
  s_add_u32 s10, s8, 73728
  s_add_u32 s11, s8, 110592
  s_mov_b32 s48, s30
  s_mov_b32 s49, s31
  s_mov_b32 s50, 9216
  s_mov_b32 s51, 0x20000
  v_lshlrev_b32 v6, 1, v5
  s_lshl_b32 s13, s63, 1
  buffer_load_ushort v24, v6, s[48:51], s13 offen
  buffer_load_ushort v25, v6, s[48:51], s13 offen offset:256
  v_add_u32 v7, 512, v4
  v_cmp_gt_u32 vcc, 16, v5
  v_mov_b32 v26, 0x40000000
  s_nop 0
  v_cndmask_b32 v7, v26, v7, vcc
  s_cmp_eq_u32 s3, 0
  s_cselect_b32 s13, 0, 0x40000000
  v_add_u32 v7, s13, v7
  s_mov_b32 s12, 65536
  s_nop 0
L_h_poll:
  buffer_load_dword v16, v4, s[52:55], s8 offen sc0 sc1
  buffer_load_dword v17, v4, s[52:55], s9 offen sc0 sc1
  buffer_load_dword v18, v4, s[52:55], s10 offen sc0 sc1
  buffer_load_dword v19, v4, s[52:55], s11 offen sc0 sc1
  buffer_load_dword v20, v7, s[52:55], s8 offen sc0 sc1
  buffer_load_dword v21, v7, s[52:55], s9 offen sc0 sc1
  buffer_load_dword v22, v7, s[52:55], s10 offen sc0 sc1
  buffer_load_dword v23, v7, s[52:55], s11 offen sc0 sc1
  s_waitcnt vmcnt(0)
  v_max3_u32 v26, v16, v17, v18
  v_max3_u32 v26, v26, v19, v20
  v_max3_u32 v26, v26, v21, v22
  v_max_u32 v26, v26, v23
  v_cmp_eq_u32 vcc, -1, v26
  s_nop 4
  s_cbranch_vccz L_h_ok
  s_sleep 16
  s_sub_u32 s12, s12, 1
  s_cmp_lg_u32 s12, 0
  s_cbranch_scc1 L_h_poll
L_h_ok:
  v_add_f32 v16, v16, v17
  v_add_f32 v18, v18, v19
  v_add_f32 v16, v16, v18
  v_lshlrev_b32 v24, 16, v24
  v_cvt_pk_bf16_f32 v16, v16, v16
  v_lshlrev_b32 v16, 16, v16
  v_add_f32 v16, v16, v24
  v_cvt_pk_bf16_f32 v16, v16, v16
  v_lshlrev_b32 v16, 16, v16
  v_max_f32 v16, 0, v16
  v_mul_f32 v16, v16, v16
  v_cvt_pk_bf16_f32 v26, v16, v16
  v_add_f32 v20, v20, v21
  v_add_f32 v22, v22, v23
  v_add_f32 v20, v20, v22
  v_lshlrev_b32 v25, 16, v25
  v_cvt_pk_bf16_f32 v20, v20, v20
  v_lshlrev_b32 v20, 16, v20
  v_add_f32 v20, v20, v25
  v_cvt_pk_bf16_f32 v20, v20, v20
  v_lshlrev_b32 v20, 16, v20
  v_max_f32 v20, 0, v20
  v_mul_f32 v20, v20, v20
  v_cvt_pk_bf16_f32 v27, v20, v20
  s_lshl_b32 s13, s3, 9
  s_add_u32 s13, s13, 9472
  v_lshl_add_u32 v6, v0, 1, s13
  ds_write_b16 v6, v26
  ds_write_b16 v6, v27 offset:128
  v_and_b32 v7, 1, v2
  v_lshlrev_b32 v7, 6, v7
  v_lshl_add_u32 v7, v3, 4, v7
  v_add_u32 v7, s13, v7
  s_waitcnt lgkmcnt(0)
  ds_read_b128 v[16:19], v7
  ds_read_b128 v[20:23], v7 offset:128
  s_waitcnt lgkmcnt(0)
  v_perm_b32 v48, v196, v192, s59
  v_perm_b32 v49, v204, v200, s59
  v_perm_b32 v50, v212, v208, s59
  v_perm_b32 v51, v220, v216, s59
  v_perm_b32 v52, v196, v192, s60
  v_perm_b32 v53, v204, v200, s60
  v_perm_b32 v54, v212, v208, s60
  v_perm_b32 v55, v220, v216, s60
  v_mfma_f32_16x16x32_bf16 v[64:67], v[16:19], v[48:51], 0
  s_nop 0
  v_mfma_f32_16x16x32_bf16 v[68:71], v[16:19], v[52:55], 0
  v_perm_b32 v56, v197, v193, s59
  v_perm_b32 v57, v205, v201, s59
  v_perm_b32 v58, v213, v209, s59
  v_perm_b32 v59, v221, v217, s59
  v_perm_b32 v60, v197, v193, s60
  v_perm_b32 v61, v205, v201, s60
  v_perm_b32 v62, v213, v209, s60
  v_perm_b32 v63, v221, v217, s60
  v_mfma_f32_16x16x32_bf16 v[72:75], v[16:19], v[56:59], 0
  s_nop 0
  v_mfma_f32_16x16x32_bf16 v[76:79], v[16:19], v[60:63], 0
  v_perm_b32 v48, v198, v194, s59
  v_perm_b32 v49, v206, v202, s59
  v_perm_b32 v50, v214, v210, s59
  v_perm_b32 v51, v222, v218, s59
  v_perm_b32 v52, v198, v194, s60
  v_perm_b32 v53, v206, v202, s60
  v_perm_b32 v54, v214, v210, s60
  v_perm_b32 v55, v222, v218, s60
  v_mfma_f32_16x16x32_bf16 v[80:83], v[16:19], v[48:51], 0
  s_nop 0
  v_mfma_f32_16x16x32_bf16 v[84:87], v[16:19], v[52:55], 0
  v_perm_b32 v56, v199, v195, s59
  v_perm_b32 v57, v207, v203, s59
  v_perm_b32 v58, v215, v211, s59
  v_perm_b32 v59, v223, v219, s59
  v_perm_b32 v60, v199, v195, s60
  v_perm_b32 v61, v207, v203, s60
  v_perm_b32 v62, v215, v211, s60
  v_perm_b32 v63, v223, v219, s60
  v_mfma_f32_16x16x32_bf16 v[88:91], v[16:19], v[56:59], 0
  s_nop 0
  v_mfma_f32_16x16x32_bf16 v[92:95], v[16:19], v[60:63], 0
  s_cmp_eq_u32 s3, 0
  s_nop 6
  s_cbranch_scc0 L_no_x2
  v_perm_b32 v48, v132, v128, s59
  v_perm_b32 v49, v140, v136, s59
  v_perm_b32 v50, v148, v144, s59
  v_perm_b32 v51, v156, v152, s59
  v_perm_b32 v52, v132, v128, s60
  v_perm_b32 v53, v140, v136, s60
  v_perm_b32 v54, v148, v144, s60
  v_perm_b32 v55, v156, v152, s60
  v_mfma_f32_16x16x32_bf16 v[64:67], v[20:23], v[48:51], v[64:67]
  s_nop 0
  v_mfma_f32_16x16x32_bf16 v[68:71], v[20:23], v[52:55], v[68:71]
  v_perm_b32 v56, v133, v129, s59
  v_perm_b32 v57, v141, v137, s59
  v_perm_b32 v58, v149, v145, s59
  v_perm_b32 v59, v157, v153, s59
  v_perm_b32 v60, v133, v129, s60
  v_perm_b32 v61, v141, v137, s60
  v_perm_b32 v62, v149, v145, s60
  v_perm_b32 v63, v157, v153, s60
  v_mfma_f32_16x16x32_bf16 v[72:75], v[20:23], v[56:59], v[72:75]
  s_nop 0
  v_mfma_f32_16x16x32_bf16 v[76:79], v[20:23], v[60:63], v[76:79]
  v_perm_b32 v48, v134, v130, s59
  v_perm_b32 v49, v142, v138, s59
  v_perm_b32 v50, v150, v146, s59
  v_perm_b32 v51, v158, v154, s59
  v_perm_b32 v52, v134, v130, s60
  v_perm_b32 v53, v142, v138, s60
  v_perm_b32 v54, v150, v146, s60
  v_perm_b32 v55, v158, v154, s60
  v_mfma_f32_16x16x32_bf16 v[80:83], v[20:23], v[48:51], v[80:83]
  s_nop 0
  v_mfma_f32_16x16x32_bf16 v[84:87], v[20:23], v[52:55], v[84:87]
  v_perm_b32 v56, v135, v131, s59
  v_perm_b32 v57, v143, v139, s59
  v_perm_b32 v58, v151, v147, s59
  v_perm_b32 v59, v159, v155, s59
  v_perm_b32 v60, v135, v131, s60
  v_perm_b32 v61, v143, v139, s60
  v_perm_b32 v62, v151, v147, s60
  v_perm_b32 v63, v159, v155, s60
  v_mfma_f32_16x16x32_bf16 v[88:91], v[20:23], v[56:59], v[88:91]
  s_nop 0
  v_mfma_f32_16x16x32_bf16 v[92:95], v[20:23], v[60:63], v[92:95]
  s_nop 7
L_no_x2:
  s_cmp_lg_u32 s3, 1
  s_cbranch_scc1 L_nobase
  s_lshl_b32 s8, s61, 1
  s_cmp_lg_u32 s8, s4
  s_cbranch_scc1 L_nobase
  s_mov_b32 s48, s34
  s_mov_b32 s49, s35
  s_mov_b32 s50, 1152
  s_mov_b32 s51, 0x20000
  s_lshl_b32 s8, s61, 7
  v_and_b32 v5, 31, v0
  v_lshlrev_b32 v5, 3, v5
  buffer_load_dwordx2 v[24:25], v5, s[48:51], s8 offen
  s_mul_i32 s9, s5, 1152
  s_add_u32 s8, s8, s9
  s_mov_b32 s44, s16
  s_mov_b32 s45, s17
  s_mov_b32 s46, 2304
  s_mov_b32 s47, 0x20000
  buffer_load_dwordx2 v[26:27], v5, s[44:47], s8 offen
  s_waitcnt vmcnt(0)
  v_lshlrev_b32 v28, 16, v24
  v_and_b32 v29, 0xffff0000, v24
  v_lshlrev_b32 v46, 16, v26
  v_and_b32 v47, 0xffff0000, v26
  v_add_f32 v28, v28, v46
  v_add_f32 v29, v29, v47
  v_lshlrev_b32 v30, 16, v25
  v_and_b32 v31, 0xffff0000, v25
  v_lshlrev_b32 v46, 16, v27
  v_and_b32 v47, 0xffff0000, v27
  v_add_f32 v30, v30, v46
  v_add_f32 v31, v31, v47
  s_nop 1
L_nobase:
  v_lshrrev_b32 v4, 5, v0
  v_lshlrev_b32 v5, 11, v4
  v_lshlrev_b32 v4, 17, v4
  v_and_b32 v6, 31, v0
  v_lshl_add_u32 v4, v6, 2, v4
  s_lshl_b32 s8, s4, 13
  s_lshl_b32 s9, s5, 9
  s_add_u32 s8, s8, s9
  s_lshl_b32 s9, s3, 7
  s_add_u32 s8, s8, s9
  s_add_u32 s9, s8, 4096
  s_lshl_b32 s10, s4, 7
  s_lshl_b32 s11, s5, 6
  s_add_u32 s10, s10, s11
  s_add_u32 s10, s10, 262144
  s_barrier
  s_cmp_lg_u32 s3, 0
  s_cbranch_scc1 L_l1
  v_lshlrev_b32 v6, 4, v0
  v_lshrrev_b32 v7, 5, v0
  v_lshlrev_b32 v7, 3, v7
  ds_read_b128 v[96:99], v6 offset:5120
  ds_read_b64 v[112:113], v7 offset:9216
  ds_read_b128 v[100:103], v6 offset:6144
  ds_read_b64 v[114:115], v7 offset:9232
  ds_read_b128 v[104:107], v6 offset:7168
  ds_read_b64 v[116:117], v7 offset:9248
  ds_read_b128 v[108:111], v6 offset:8192
  ds_read_b64 v[118:119], v7 offset:9264
  s_lshl_b32 s12, s7, 13
  s_lshl_b32 s13, s6, 10
  s_add_u32 s12, s12, s13
  s_lshl_b32 s13, s7, 7
  s_lshl_b32 s14, s6, 3
  s_add_u32 s13, s13, s14
  s_add_u32 s13, s13, 262144
  v_lshlrev_b32 v7, 1, v0
  s_waitcnt lgkmcnt(0)
  v_max3_f32 v120, v112, v114, v116
  v_max_f32 v120, v120, v118
  v_sub_f32 v122, v112, v120
  v_sub_f32 v123, v114, v120
  v_sub_f32 v124, v116, v120
  v_sub_f32 v125, v118, v120
  v_mul_f32 v122, s58, v122
  v_mul_f32 v123, s58, v123
  v_mul_f32 v124, s58, v124
  v_mul_f32 v125, s58, v125
  v_exp_f32 v122, v122
  v_exp_f32 v123, v123
  v_exp_f32 v124, v124
  v_exp_f32 v125, v125
  v_mul_f32 v121, v122, v113
  v_mul_f32 v128, v122, v96
  v_mul_f32 v129, v122, v97
  v_mul_f32 v130, v122, v98
  v_mul_f32 v131, v122, v99
  v_fmac_f32 v121, v123, v115
  v_fmac_f32 v128, v123, v100
  v_fmac_f32 v129, v123, v101
  v_fmac_f32 v130, v123, v102
  v_fmac_f32 v131, v123, v103
  v_fmac_f32 v121, v124, v117
  v_fmac_f32 v128, v124, v104
  v_fmac_f32 v129, v124, v105
  v_fmac_f32 v130, v124, v106
  v_fmac_f32 v131, v124, v107
  v_fmac_f32 v121, v125, v119
  v_fmac_f32 v128, v125, v108
  v_fmac_f32 v129, v125, v109
  v_fmac_f32 v130, v125, v110
  v_fmac_f32 v131, v125, v111
  v_min_u32 v128, -2, v128
  v_min_u32 v129, -2, v129
  v_min_u32 v130, -2, v130
  v_min_u32 v131, -2, v131
  v_min_u32 v120, -2, v120
  v_min_u32 v121, -2, v121
  buffer_store_dwordx4 v[128:131], v6, s[52:55], s12 offen sc0 sc1
  s_mov_b32 exec_lo, 1
  s_mov_b32 exec_hi, 1
  buffer_store_dwordx2 v[120:121], v7, s[52:55], s13 offen sc0 sc1
  s_mov_b64 exec, -1
  v_lshrrev_b32 v132, 2, v0
  v_lshlrev_b32 v132, 11, v132
  v_and_b32 v133, 3, v0
  v_lshl_add_u32 v132, v133, 4, v132
  v_cmp_gt_u32 vcc, 8, v0
  v_mov_b32 v133, 0x40000000
  s_nop 0
  v_cndmask_b32 v132, v133, v132, vcc
  s_mov_b32 s12, 65536
  s_nop 0
L_lp_poll:
  buffer_load_dwordx4 v[136:139], v132, s[52:55], s10 offen sc0 sc1
  s_waitcnt vmcnt(0)
  v_max3_u32 v133, v136, v137, v138
  v_max_u32 v133, v133, v139
  v_cmp_eq_u32 vcc, -1, v133
  s_nop 4
  s_cbranch_vccz L_lp_ok
  s_sleep 1
  s_sub_u32 s12, s12, 1
  s_cmp_lg_u32 s12, 0
  s_cbranch_scc1 L_lp_poll
L_lp_ok:
L_l1:
  s_barrier
  s_lshl_b32 s13, s3, 9
  s_add_u32 s13, s13, 9472
  v_lshl_add_u32 v6, v0, 1, s13
  v_and_b32 v7, 1, v2
  v_lshlrev_b32 v7, 6, v7
  v_lshl_add_u32 v7, v3, 4, v7
  v_add_u32 v7, s13, v7
  s_mov_b32 s12, 65536
  s_nop 0
L_l1_poll:
  buffer_load_dword v96, v4, s[52:55], s8 offen offset:0 sc0 sc1
  buffer_load_dword v97, v4, s[52:55], s8 offen offset:1024 sc0 sc1
  buffer_load_dword v98, v4, s[52:55], s8 offen offset:2048 sc0 sc1
  buffer_load_dword v99, v4, s[52:55], s8 offen offset:3072 sc0 sc1
  buffer_load_dword v100, v4, s[52:55], s9 offen offset:0 sc0 sc1
  buffer_load_dword v101, v4, s[52:55], s9 offen offset:1024 sc0 sc1
  buffer_load_dword v102, v4, s[52:55], s9 offen offset:2048 sc0 sc1
  buffer_load_dword v103, v4, s[52:55], s9 offen offset:3072 sc0 sc1
  buffer_load_dwordx4 v[104:107], v5, s[52:55], s10 offen offset:0 sc0 sc1
  buffer_load_dwordx4 v[108:111], v5, s[52:55], s10 offen offset:16 sc0 sc1
  buffer_load_dwordx4 v[112:115], v5, s[52:55], s10 offen offset:32 sc0 sc1
  buffer_load_dwordx4 v[116:119], v5, s[52:55], s10 offen offset:48 sc0 sc1
  s_waitcnt vmcnt(0)
  v_max3_u32 v120, v96, v97, v98
  v_max3_u32 v120, v120, v99, v100
  v_max3_u32 v120, v120, v101, v102
  v_max3_u32 v120, v120, v103, v104
  v_max3_u32 v120, v120, v105, v106
  v_max3_u32 v120, v120, v107, v108
  v_max3_u32 v120, v120, v109, v110
  v_max3_u32 v120, v120, v111, v112
  v_max3_u32 v120, v120, v113, v114
  v_max3_u32 v120, v120, v115, v116
  v_max3_u32 v120, v120, v117, v118
  v_max_u32 v120, v120, v119
  v_cmp_eq_u32 vcc, -1, v120
  s_nop 4
  s_cbranch_vccz L_l1_ok
  s_sleep 1
  s_sub_u32 s12, s12, 1
  s_cmp_lg_u32 s12, 0
  s_cbranch_scc1 L_l1_poll
L_l1_ok:
  v_max3_f32 v120, v104, v106, v108
  v_max3_f32 v120, v120, v110, v112
  v_max3_f32 v120, v120, v114, v116
  v_max_f32 v120, v120, v118
  v_sub_f32 v122, v104, v120
  v_sub_f32 v123, v106, v120
  v_sub_f32 v124, v108, v120
  v_sub_f32 v125, v110, v120
  v_sub_f32 v126, v112, v120
  v_sub_f32 v127, v114, v120
  v_sub_f32 v128, v116, v120
  v_sub_f32 v129, v118, v120
  v_mul_f32 v122, s58, v122
  v_mul_f32 v123, s58, v123
  v_mul_f32 v124, s58, v124
  v_mul_f32 v125, s58, v125
  v_mul_f32 v126, s58, v126
  v_mul_f32 v127, s58, v127
  v_mul_f32 v128, s58, v128
  v_mul_f32 v129, s58, v129
  v_exp_f32 v122, v122
  v_exp_f32 v123, v123
  v_exp_f32 v124, v124
  v_exp_f32 v125, v125
  v_exp_f32 v126, v126
  v_exp_f32 v127, v127
  v_exp_f32 v128, v128
  v_exp_f32 v129, v129
  v_mul_f32 v121, v122, v105
  v_mul_f32 v130, v122, v96
  v_fmac_f32 v121, v123, v107
  v_fmac_f32 v130, v123, v97
  v_fmac_f32 v121, v124, v109
  v_fmac_f32 v130, v124, v98
  v_fmac_f32 v121, v125, v111
  v_fmac_f32 v130, v125, v99
  v_fmac_f32 v121, v126, v113
  v_fmac_f32 v130, v126, v100
  v_fmac_f32 v121, v127, v115
  v_fmac_f32 v130, v127, v101
  v_fmac_f32 v121, v128, v117
  v_fmac_f32 v130, v128, v102
  v_fmac_f32 v121, v129, v119
  v_fmac_f32 v130, v129, v103
  v_rcp_f32 v121, v121
  s_nop 0
  v_mul_f32 v130, v130, v121
  v_cvt_pk_bf16_f32 v130, v130, v130
  ds_write_b16 v6, v130
  s_waitcnt lgkmcnt(0)
  ds_read_b128 v[132:135], v7
  s_waitcnt lgkmcnt(0)
  v_mfma_f32_16x16x32_bf16 v[64:67], v[132:135], v[160:163], v[64:67]
  v_mfma_f32_16x16x32_bf16 v[68:71], v[132:135], v[164:167], v[68:71]
  v_mfma_f32_16x16x32_bf16 v[72:75], v[132:135], v[168:171], v[72:75]
  v_mfma_f32_16x16x32_bf16 v[76:79], v[132:135], v[172:175], v[76:79]
  v_mfma_f32_16x16x32_bf16 v[80:83], v[132:135], v[176:179], v[80:83]
  v_mfma_f32_16x16x32_bf16 v[84:87], v[132:135], v[180:183], v[84:87]
  v_mfma_f32_16x16x32_bf16 v[88:91], v[132:135], v[184:187], v[88:91]
  v_mfma_f32_16x16x32_bf16 v[92:95], v[132:135], v[188:191], v[92:95]
  s_lshl_b32 s12, s3, 10
  s_add_u32 s12, s12, 1024
  v_lshl_add_u32 v6, v2, 5, s12
  s_mov_b64 exec, 0xffff
  ds_write2_b32 v6, v64, v68 offset0:0 offset1:1
  ds_write2_b32 v6, v72, v76 offset0:2 offset1:3
  ds_write2_b32 v6, v80, v84 offset0:4 offset1:5
  s_nop 0
  ds_write2_b32 v6, v88, v92 offset0:6 offset1:7
  ds_write2_b32 v6, v65, v69 offset0:128 offset1:129
  ds_write2_b32 v6, v73, v77 offset0:130 offset1:131
  ds_write2_b32 v6, v81, v85 offset0:132 offset1:133
  ds_write2_b32 v6, v89, v93 offset0:134 offset1:135
  s_mov_b64 exec, -1
  s_waitcnt lgkmcnt(0)
  s_barrier
  s_cmp_eq_u32 s3, 1
  s_cbranch_scc1 L_final
  s_cmp_lg_u32 s3, 0
  s_cbranch_scc1 L_endaux
  v_lshlrev_b32 v6, 4, v0
  ds_read_b128 v[136:139], v6 offset:1024
  ds_read_b128 v[140:143], v6 offset:2048
  ds_read_b128 v[144:147], v6 offset:3072
  ds_read_b128 v[148:151], v6 offset:4096
  s_lshl_b32 s13, s61, 15
  s_lshl_b32 s14, s4, 10
  s_add_u32 s13, s13, s14
  s_lshl_b32 s14, s5, 9
  s_add_u32 s13, s13, s14
  s_add_u32 s13, s13, 589824
  v_lshrrev_b32 v11, 5, v0
  v_lshlrev_b32 v11, 14, v11
  v_and_b32 v7, 31, v0
  v_lshl_add_u32 v11, v7, 4, v11
  s_mov_b32 s14, 0x0000ffff
  s_cmp_eq_u32 s61, 7
  s_cselect_b32 s14, -1, s14
  s_waitcnt lgkmcnt(0)
  v_add_f32 v136, v136, v140
  v_add_f32 v144, v144, v148
  v_add_f32 v137, v137, v141
  v_add_f32 v145, v145, v149
  v_add_f32 v138, v138, v142
  v_add_f32 v146, v146, v150
  v_add_f32 v139, v139, v143
  v_add_f32 v147, v147, v151
  v_add_f32 v136, v136, v144
  v_add_f32 v137, v137, v145
  v_add_f32 v138, v138, v146
  v_add_f32 v139, v139, v147
  v_min_u32 v136, -2, v136
  v_min_u32 v137, -2, v137
  v_min_u32 v138, -2, v138
  v_min_u32 v139, -2, v139
  s_mov_b32 exec_lo, s14
  s_mov_b32 exec_hi, s14
  buffer_store_dwordx4 v[136:139], v11, s[52:55], s13 offen sc0 sc1
  s_nop 1
  s_branch L_endaux
L_final:
  s_lshl_b32 s8, s61, 1
  s_cmp_lg_u32 s8, s4
  s_cbranch_scc1 L_endaux
  s_lshl_b32 s8, s61, 15
  s_lshl_b32 s9, s5, 14
  s_add_u32 s8, s8, s9
  s_add_u32 s8, s8, 589824
  s_add_u32 s9, s8, 4096
  v_lshrrev_b32 v4, 5, v0
  v_lshlrev_b32 v4, 13, v4
  v_and_b32 v5, 31, v0
  v_lshl_add_u32 v4, v5, 4, v4
  s_mov_b32 s14, 0x0000ffff
  s_cmp_eq_u32 s61, 7
  s_cselect_b32 s14, -1, s14
  s_mov_b32 exec_lo, s14
  s_mov_b32 exec_hi, s14
  s_mov_b32 s12, 65536
L_fin_poll:
  buffer_load_dwordx4 v[96:99], v4, s[52:55], s8 offen offset:0 sc0 sc1
  buffer_load_dwordx4 v[100:103], v4, s[52:55], s8 offen offset:512 sc0 sc1
  buffer_load_dwordx4 v[104:107], v4, s[52:55], s8 offen offset:1024 sc0 sc1
  buffer_load_dwordx4 v[108:111], v4, s[52:55], s8 offen offset:1536 sc0 sc1
  buffer_load_dwordx4 v[112:115], v4, s[52:55], s8 offen offset:2048 sc0 sc1
  buffer_load_dwordx4 v[116:119], v4, s[52:55], s8 offen offset:2560 sc0 sc1
  buffer_load_dwordx4 v[120:123], v4, s[52:55], s8 offen offset:3072 sc0 sc1
  buffer_load_dwordx4 v[124:127], v4, s[52:55], s8 offen offset:3584 sc0 sc1
  buffer_load_dwordx4 v[128:131], v4, s[52:55], s9 offen offset:0 sc0 sc1
  buffer_load_dwordx4 v[132:135], v4, s[52:55], s9 offen offset:512 sc0 sc1
  buffer_load_dwordx4 v[136:139], v4, s[52:55], s9 offen offset:1024 sc0 sc1
  buffer_load_dwordx4 v[140:143], v4, s[52:55], s9 offen offset:1536 sc0 sc1
  buffer_load_dwordx4 v[144:147], v4, s[52:55], s9 offen offset:2048 sc0 sc1
  buffer_load_dwordx4 v[148:151], v4, s[52:55], s9 offen offset:2560 sc0 sc1
  buffer_load_dwordx4 v[152:155], v4, s[52:55], s9 offen offset:3072 sc0 sc1
  buffer_load_dwordx4 v[156:159], v4, s[52:55], s9 offen offset:3584 sc0 sc1
  s_waitcnt vmcnt(0)
  v_max3_u32 v160, v96, v97, v98
  v_max3_u32 v160, v160, v99, v100
  v_max3_u32 v160, v160, v101, v102
  v_max3_u32 v160, v160, v103, v104
  v_max3_u32 v160, v160, v105, v106
  v_max3_u32 v160, v160, v107, v108
  v_max3_u32 v160, v160, v109, v110
  v_max3_u32 v160, v160, v111, v112
  v_max3_u32 v160, v160, v113, v114
  v_max3_u32 v160, v160, v115, v116
  v_max3_u32 v160, v160, v117, v118
  v_max3_u32 v160, v160, v119, v120
  v_max3_u32 v160, v160, v121, v122
  v_max3_u32 v160, v160, v123, v124
  v_max3_u32 v160, v160, v125, v126
  v_max3_u32 v160, v160, v127, v128
  v_max3_u32 v160, v160, v129, v130
  v_max3_u32 v160, v160, v131, v132
  v_max3_u32 v160, v160, v133, v134
  v_max3_u32 v160, v160, v135, v136
  v_max3_u32 v160, v160, v137, v138
  v_max3_u32 v160, v160, v139, v140
  v_max3_u32 v160, v160, v141, v142
  v_max3_u32 v160, v160, v143, v144
  v_max3_u32 v160, v160, v145, v146
  v_max3_u32 v160, v160, v147, v148
  v_max3_u32 v160, v160, v149, v150
  v_max3_u32 v160, v160, v151, v152
  v_max3_u32 v160, v160, v153, v154
  v_max3_u32 v160, v160, v155, v156
  v_max3_u32 v160, v160, v157, v158
  v_max_u32 v160, v160, v159
  v_cmp_eq_u32 vcc, -1, v160
  s_nop 4
  s_cbranch_vccz L_fin_ok
  s_sleep 1
  s_sub_u32 s12, s12, 1
  s_cmp_lg_u32 s12, 0
  s_cbranch_scc1 L_fin_poll
L_fin_ok:
  v_add_f32 v96, v96, v100
  v_add_f32 v97, v97, v101
  v_add_f32 v98, v98, v102
  v_add_f32 v99, v99, v103
  v_add_f32 v104, v104, v108
  v_add_f32 v105, v105, v109
  v_add_f32 v106, v106, v110
  v_add_f32 v107, v107, v111
  v_add_f32 v112, v112, v116
  v_add_f32 v113, v113, v117
  v_add_f32 v114, v114, v118
  v_add_f32 v115, v115, v119
  v_add_f32 v120, v120, v124
  v_add_f32 v121, v121, v125
  v_add_f32 v122, v122, v126
  v_add_f32 v123, v123, v127
  v_add_f32 v128, v128, v132
  v_add_f32 v129, v129, v133
  v_add_f32 v130, v130, v134
  v_add_f32 v131, v131, v135
  v_add_f32 v136, v136, v140
  v_add_f32 v137, v137, v141
  v_add_f32 v138, v138, v142
  v_add_f32 v139, v139, v143
  v_add_f32 v144, v144, v148
  v_add_f32 v145, v145, v149
  v_add_f32 v146, v146, v150
  v_add_f32 v147, v147, v151
  v_add_f32 v152, v152, v156
  v_add_f32 v153, v153, v157
  v_add_f32 v154, v154, v158
  v_add_f32 v155, v155, v159
  v_add_f32 v96, v96, v104
  v_add_f32 v97, v97, v105
  v_add_f32 v98, v98, v106
  v_add_f32 v99, v99, v107
  v_add_f32 v112, v112, v120
  v_add_f32 v113, v113, v121
  v_add_f32 v114, v114, v122
  v_add_f32 v115, v115, v123
  v_add_f32 v128, v128, v136
  v_add_f32 v129, v129, v137
  v_add_f32 v130, v130, v138
  v_add_f32 v131, v131, v139
  v_add_f32 v144, v144, v152
  v_add_f32 v145, v145, v153
  v_add_f32 v146, v146, v154
  v_add_f32 v147, v147, v155
  v_add_f32 v96, v96, v112
  v_add_f32 v97, v97, v113
  v_add_f32 v98, v98, v114
  v_add_f32 v99, v99, v115
  v_add_f32 v128, v128, v144
  v_add_f32 v129, v129, v145
  v_add_f32 v130, v130, v146
  v_add_f32 v131, v131, v147
  v_add_f32 v164, v96, v128
  v_add_f32 v165, v97, v129
  v_add_f32 v166, v98, v130
  v_add_f32 v167, v99, v131
  s_mov_b64 exec, -1
  v_mov_b32 v160, v164
  s_nop 1
  v_permlane32_swap_b32 v164, v160
  v_add_f32 v164, v164, v160
  v_mov_b32 v161, v165
  s_nop 1
  v_permlane32_swap_b32 v165, v161
  v_add_f32 v165, v165, v161
  v_mov_b32 v162, v166
  s_nop 1
  v_permlane32_swap_b32 v166, v162
  v_add_f32 v166, v166, v162
  v_mov_b32 v163, v167
  s_nop 1
  v_permlane32_swap_b32 v167, v163
  v_add_f32 v167, v167, v163
  v_add_f32 v164, v164, v28
  v_add_f32 v165, v165, v29
  v_add_f32 v166, v166, v30
  v_add_f32 v167, v167, v31
  v_cvt_pk_bf16_f32 v168, v164, v165
  v_cvt_pk_bf16_f32 v169, v166, v167
  s_mov_b32 s48, s36
  s_mov_b32 s49, s37
  s_mov_b32 s50, 2304
  s_mov_b32 s51, 0x20000
  s_lshl_b32 s8, s61, 7
  s_mul_i32 s9, s5, 1152
  s_add_u32 s8, s8, s9
  v_lshlrev_b32 v5, 3, v5
  s_mov_b32 exec_lo, s14
  s_mov_b32 exec_hi, 0
  buffer_store_dwordx2 v[168:169], v5, s[48:51], s8 offen
L_endaux:
L_end:
  s_endpgm
.section .rodata,"a"
.p2align 6
.amdhsa_kernel parallel_sum__gqa_block_cached__dense_activation_squared_relu__decode_kernel
  .amdhsa_next_free_vgpr 256
  .amdhsa_next_free_sgpr 102
  .amdhsa_accum_offset 256
  .amdhsa_group_segment_fixed_size 0
  .amdhsa_kernarg_size 104
  .amdhsa_user_sgpr_count 2
  .amdhsa_user_sgpr_kernarg_segment_ptr 1
  .amdhsa_system_sgpr_workgroup_id_x 1
.end_amdhsa_kernel
```
